```python
import torch

def _softmax(x, axis=-1):
    return torch.softmax(x, dim=axis)
def _gelu(x):
    return torch.nn.functional.gelu(x, approximate="tanh")
def _silu(x):
    return torch.nn.functional.silu(x)
def _sigmoid(x):
    return torch.sigmoid(x)
def _layernorm(x, axis=-1, eps=1e-5):
    m = x.mean(dim=axis, keepdim=True)
    v = x.var(dim=axis, keepdim=True, unbiased=False)
    return (x - m) / torch.sqrt(v + eps)
def _scatter_add(tgt, idx, src, axis=0):
    return tgt.clone().index_add_(axis, idx, src)
def _segment_sum(src, seg, n):
    out = torch.zeros((n,) + src.shape[1:], dtype=src.dtype)
    return out.index_add_(0, seg, src)
def _pad(x, pw):
    flat = tuple(v for pair in reversed(pw) for v in pair)
    return torch.nn.functional.pad(x, flat)

kernel_name = 'parallel_sum__sliding_block_cached__glu_gated_glu__decode'

def setup_inputs():

    _w = (lambda a: (lambda t: t.to(torch.bfloat16) if t.is_floating_point() else t)(torch.as_tensor(a)))
    def _A_setup():
        B, Sq, D = 2, 1, 512
        Hq, Hkv, Sk, Dh = 32, 32, 4096, 128
        assert Hq % Hkv == 0, (Hq, Hkv)
        return {
            "x": _w((lambda *s: torch.randn(*s, dtype=torch.bfloat16) * 0.05)(B, Sq, D)),
            "k_cache": _w((lambda *s: torch.randn(*s, dtype=torch.bfloat16) * 3.2)(B, Hkv, Sk, Dh)),
            "v_cache": _w((lambda *s: torch.randn(*s, dtype=torch.bfloat16) * 1.6)(B, Hkv, Sk, Dh)),
            "wq": _w((lambda *s: torch.randn(*s, dtype=torch.bfloat16) * 3.2)(D, Hq * Dh) * (D ** -0.5)),
            "wo": _w((lambda *s: torch.randn(*s, dtype=torch.bfloat16) * 1.6)(Hq * Dh, D) * ((Hq * Dh) ** -0.5)),
        }
    _A_in = _A_setup()

    def _B_setup():
        B, S, D, F = 2, 1, 512, 1376
        return {
            "x": _w((lambda *s: torch.randn(*s, dtype=torch.bfloat16) * 0.05)(B, S, D)),
            "w_gate": _w((lambda *s: torch.randn(*s, dtype=torch.bfloat16) * 0.2)(D, F)),
            "w_up": _w((lambda *s: torch.randn(*s, dtype=torch.bfloat16) * 0.05)(D, F)),
            "w_down": _w((lambda *s: torch.randn(*s, dtype=torch.bfloat16) * 0.05)(F, D)),
        }
    _B_in = _B_setup()

    return {
        "A_x": _A_in["x"],
        "A_k_cache": _A_in["k_cache"],
        "A_v_cache": _A_in["v_cache"],
        "A_wq": _A_in["wq"],
        "A_wo": _A_in["wo"],
        "B_x": _B_in["x"],
        "B_w_gate": _B_in["w_gate"],
        "B_w_up": _B_in["w_up"],
        "B_w_down": _B_in["w_down"],
    }

def reference(A_x, A_k_cache, A_v_cache, A_wq, A_wo, B_x, B_w_gate, B_w_up, B_w_down):
    def _A_ref(x, k_cache, v_cache, wq, wo):
        B, Sq, D = x.shape
        Hq, Dh = 32, 128
        Hkv, Sk = k_cache.shape[1], k_cache.shape[2]
        W = min(4096, max(256, Sk // 4))
        rep = Hq // Hkv
        q = (lambda x, *d: x.permute(*d))((x @ wq).reshape(B, Sq, Hq, Dh), 0, 2, 1, 3)
        k = (lambda x, n, axis: torch.repeat_interleave(x, n, dim=axis))(k_cache[:, :, Sk - W:, :], rep, axis=1)
        v = (lambda x, n, axis: torch.repeat_interleave(x, n, dim=axis))(v_cache[:, :, Sk - W:, :], rep, axis=1)
        scores = torch.einsum("bhqd,bhkd->bhqk", q, k) * (Dh ** -0.5)
        p = _softmax(scores, axis=-1)
        o = torch.einsum("bhqk,bhkd->bhqd", p, v)
        return (lambda x, *d: x.permute(*d))(o, 0, 2, 1, 3).reshape(B, Sq, Hq * Dh) @ wo

    def _B_ref(x, w_gate, w_up, w_down):
        g = torch.einsum("bsd,df->bsf", x, w_gate)
        u = torch.einsum("bsd,df->bsf", x, w_up)
        h = _sigmoid(g) * u
        return torch.einsum("bsf,fd->bsd", h, w_down)

    x = A_x
    xn = _layernorm(x, axis=-1)
    return x + _A_ref(xn, A_k_cache, A_v_cache, A_wq, A_wo) + _B_ref(xn, B_w_gate, B_w_up, B_w_down)
```

```asm
; @launch grid=(256,1,1) block=(704,1,1) lds=4608
.amdgcn_target "amdgcn-amd-amdhsa--gfx950"
.text
.globl parallel_sum__sliding_block_cached__glu_gated_glu__decode_kernel
.p2align 8
.type parallel_sum__sliding_block_cached__glu_gated_glu__decode_kernel,@function
parallel_sum__sliding_block_cached__glu_gated_glu__decode_kernel:
  s_load_dwordx16 s[4:19], s[0:1], 0
  s_load_dwordx8 s[20:27], s[0:1], 64
  v_lshrrev_b32 v6, 6, v0
  s_cmp_ge_u32 s2, 256
  v_readfirstlane_b32 s30, v6
  s_cbranch_scc1 L_end
  v_and_b32 v1, 63, v0
  s_and_b32 s28, s2, 7
  s_lshl_b32 s28, s28, 2
  s_lshr_b32 s29, s2, 6
  s_add_u32 s28, s28, s29
  s_bfe_u32 s29, s2, 0x30003
  s_lshr_b32 s32, s29, 2
  s_and_b32 s33, s29, 3
  s_lshl_b32 s35, s28, 3
  s_add_u32 s35, s35, s29
  s_mov_b32 s34, 0x100000
  v_and_b32 v2, 15, v1
  v_lshrrev_b32 v3, 4, v1
  v_mov_b32 v4, 0
  v_mov_b32 v5, 0xff
  s_cmp_lt_u32 s30, 2
  s_cbranch_scc1 L_P
  s_getpc_b64 s[96:97]
L_wpc_1:
  s_sub_u32 s98, s30, 6
  s_lshl_b32 s98, s98, 5
  s_lshr_b32 s99, s2, 3
  s_add_u32 s98, s98, s99
  s_cmp_ge_u32 s98, 86
  s_cbranch_scc1 L_w1_done
  s_lshl_b32 s98, s98, 7
  s_add_u32 s96, s96, 0x88
  s_addc_u32 s97, s97, 0
  s_add_u32 s98, s98, s96
  s_addc_u32 s99, s97, 0
  s_mov_b64 exec, 0
  s_swappc_b64 s[100:101], s[98:99]
  s_mov_b64 exec, -1
L_w1_done:
  s_cmp_eq_u32 s30, 10
  s_cbranch_scc1 L_T
  s_branch L_S
L_wret:
  s_setpc_b64 s[100:101]
L_P:
  s_setprio 2
  s_mov_b32 s54, 0x89868380
  s_mov_b32 s55, 0x55928f8c
  s_bitcmp1_b32 s28, 4
  s_cselect_b32 s54, 0x5f9c5a97, s54
  s_cselect_b32 s55, 0x69a664a1, s55
  s_lshl_b32 s56, s28, 2
  s_and_b32 s56, s56, 56
  s_lshr_b64 s[54:55], s[54:55], s56
  s_nop 0
  s_cbranch_execz L_wret
  s_bfe_u32 s90, s54, 0x20006
  s_add_u32 s90, s90, 1
  s_and_b32 s91, s54, 63
  s_lshl_b32 s54, s90, 2
  s_lshl_b32 s53, s91, 6
  s_lshl_b32 s56, s28, 8
  s_cmp_eq_u32 s30, 0
  s_movk_i32 s52, 2752
  s_mov_b32 s42, 1409024
  s_cselect_b32 s52, 8192, s52
  s_cselect_b32 s53, s56, s53
  s_cselect_b32 s54, 16, s54
  s_cselect_b32 s42, 0x400000, s42
  s_lshl_b32 s56, s29, 6
  s_mul_i32 s56, s56, s52
  s_add_u32 s53, s53, s56
  s_lshl_b32 s56, s52, 4
  v_mul_lo_u32 v6, v3, s56
  v_lshl_add_u32 v6, v2, 4, v6
  v_cmp_gt_i32 vcc, s54, v2
  v_mov_b32 v7, 0x80000000
  s_nop 0
  v_cndmask_b32 v6, v7, v6, vcc
  v_lshrrev_b32 v9, 3, v2
  s_cbranch_execz L_wret
  v_and_b32 v26, 7, v2
  v_lshlrev_b32 v9, 10, v9
  v_lshl_add_u32 v7, v3, 8, v9
  v_lshl_add_u32 v7, v26, 5, v7
  v_lshl_add_u32 v8, v3, 5, v9
  v_lshl_add_u32 v8, v26, 2, v8
  s_lshl_b32 s56, s29, 7
  s_mov_b32 s46, 2048
  s_mov_b32 s47, 0x20000
  s_mov_b32 s43, 0x20000
  s_bitcmp1_b32 s28, 0
  s_waitcnt lgkmcnt(0)
  s_mov_b32 s44, s4
  s_mov_b32 s45, s5
  buffer_load_dwordx4 v[18:21], v7, s[44:47], 0 offen
  buffer_load_dwordx4 v[22:25], v7, s[44:47], 0 offen offset:16
  buffer_load_dword v26, v8, s[44:47], s56 offen
  s_cselect_b32 s40, s18, s16
  s_cselect_b32 s41, s19, s17
  s_cmp_eq_u32 s30, 0
  s_cselect_b32 s40, s10, s40
  s_cbranch_execz L_wret
  s_cselect_b32 s41, s11, s41
  buffer_load_dwordx4 v[96:99], v6, s[40:43], s53 offen nt
  s_add_u32 s53, s53, s52
  buffer_load_dwordx4 v[100:103], v6, s[40:43], s53 offen nt
  s_add_u32 s53, s53, s52
  buffer_load_dwordx4 v[104:107], v6, s[40:43], s53 offen nt
  s_add_u32 s53, s53, s52
  buffer_load_dwordx4 v[108:111], v6, s[40:43], s53 offen nt
  s_add_u32 s53, s53, s52
  buffer_load_dwordx4 v[112:115], v6, s[40:43], s53 offen nt
  s_add_u32 s53, s53, s52
  buffer_load_dwordx4 v[116:119], v6, s[40:43], s53 offen nt
  s_add_u32 s53, s53, s52
  buffer_load_dwordx4 v[120:123], v6, s[40:43], s53 offen nt
  s_add_u32 s53, s53, s52
  buffer_load_dwordx4 v[124:127], v6, s[40:43], s53 offen nt
  s_add_u32 s53, s53, s52
  buffer_load_dwordx4 v[128:131], v6, s[40:43], s53 offen nt
  s_add_u32 s53, s53, s52
  buffer_load_dwordx4 v[132:135], v6, s[40:43], s53 offen nt
  s_add_u32 s53, s53, s52
  s_cbranch_execz L_wret
  buffer_load_dwordx4 v[136:139], v6, s[40:43], s53 offen nt
  s_add_u32 s53, s53, s52
  buffer_load_dwordx4 v[140:143], v6, s[40:43], s53 offen nt
  s_add_u32 s53, s53, s52
  buffer_load_dwordx4 v[144:147], v6, s[40:43], s53 offen nt
  s_add_u32 s53, s53, s52
  buffer_load_dwordx4 v[148:151], v6, s[40:43], s53 offen nt
  s_add_u32 s53, s53, s52
  buffer_load_dwordx4 v[152:155], v6, s[40:43], s53 offen nt
  s_add_u32 s53, s53, s52
  buffer_load_dwordx4 v[156:159], v6, s[40:43], s53 offen nt
  s_barrier
  s_load_dword s31, s[26:27], 0
  s_mov_b32 s36, s26
  s_mov_b32 s37, s27
  s_mov_b32 s38, 0x200000
  s_mov_b32 s39, 0x20000
  s_getreg_b32 s59, hwreg(HW_REG_XCC_ID, 0, 4)
  v_and_b32 v27, 1, v2
  v_cmp_eq_u32 vcc, 1, v27
  v_bfe_u32 v27, v2, 1, 2
  s_cbranch_execz L_wret
  v_mov_b32 v30, 0x0c0c0c0c
  v_mov_b32 v10, 0xc0c0100
  v_mov_b32 v11, 0x1000c0c
  v_cndmask_b32 v28, v10, v11, vcc
  v_mov_b32 v10, 0xc0c0302
  v_mov_b32 v11, 0x3020c0c
  v_cndmask_b32 v29, v10, v11, vcc
  v_cmp_eq_u32 vcc, 0, v27
  s_nop 1
  v_cndmask_b32 v10, v30, v28, vcc
  v_cndmask_b32 v14, v30, v29, vcc
  v_cmp_eq_u32 vcc, 1, v27
  s_nop 1
  v_cndmask_b32 v11, v30, v28, vcc
  v_cndmask_b32 v15, v30, v29, vcc
  v_cmp_eq_u32 vcc, 2, v27
  s_nop 1
  v_cndmask_b32 v12, v30, v28, vcc
  v_cndmask_b32 v16, v30, v29, vcc
  v_cmp_eq_u32 vcc, 3, v27
  s_nop 1
  v_cndmask_b32 v13, v30, v28, vcc
  v_cndmask_b32 v17, v30, v29, vcc
  v_mov_b32 v27, 0x3f803f80
  s_waitcnt vmcnt(16)
  s_cbranch_execz L_wret
  v_dot2_f32_bf16 v28, v18, v27, 0
  v_dot2_f32_bf16 v30, v18, v18, 0
  v_dot2_f32_bf16 v28, v19, v27, v28
  v_dot2_f32_bf16 v30, v19, v19, v30
  v_dot2_f32_bf16 v28, v20, v27, v28
  v_dot2_f32_bf16 v30, v20, v20, v30
  v_dot2_f32_bf16 v28, v21, v27, v28
  v_dot2_f32_bf16 v30, v21, v21, v30
  v_dot2_f32_bf16 v28, v22, v27, v28
  v_dot2_f32_bf16 v30, v22, v22, v30
  v_dot2_f32_bf16 v28, v23, v27, v28
  v_dot2_f32_bf16 v30, v23, v23, v30
  v_dot2_f32_bf16 v28, v24, v27, v28
  v_dot2_f32_bf16 v30, v24, v24, v30
  v_dot2_f32_bf16 v28, v25, v27, v28
  s_nop 0
  s_cbranch_execz L_wret
  v_dot2_f32_bf16 v30, v25, v25, v30
  s_nop 1
  v_add_f32_dpp v28, v28, v28 quad_perm:[1,0,3,2] row_mask:0xf bank_mask:0xf
  v_add_f32_dpp v30, v30, v30 quad_perm:[1,0,3,2] row_mask:0xf bank_mask:0xf
  s_nop 0
  v_add_f32_dpp v28, v28, v28 quad_perm:[2,3,0,1] row_mask:0xf bank_mask:0xf
  v_add_f32_dpp v30, v30, v30 quad_perm:[2,3,0,1] row_mask:0xf bank_mask:0xf
  s_nop 0
  v_add_f32_dpp v28, v28, v28 row_half_mirror row_mask:0xf bank_mask:0xf
  v_add_f32_dpp v30, v30, v30 row_half_mirror row_mask:0xf bank_mask:0xf
  v_mov_b32 v29, v28
  v_mov_b32 v31, v30
  s_nop 0
  v_permlane16_swap_b32 v28, v29
  v_permlane16_swap_b32 v30, v31
  v_add_f32 v28, v28, v29
  v_add_f32 v30, v30, v31
  v_mov_b32 v29, v28
  v_mov_b32 v31, v30
  s_nop 0
  v_permlane32_swap_b32 v28, v29
  v_permlane32_swap_b32 v30, v31
  v_add_f32 v28, v28, v29
  v_add_f32 v30, v30, v31
  s_cbranch_execz L_wret
  v_mul_f32 v28, 0x3b000000, v28
  v_mul_f32 v30, 0x3b000000, v30
  v_fma_f32 v30, -v28, v28, v30
  v_max_f32 v30, 0, v30
  v_cvt_pk_bf16_f32 v28, v28, v30
  v_and_b32 v30, 0xffff0000, v28
  v_lshlrev_b32 v28, 16, v28
  v_add_f32 v30, 0x3727c5ac, v30
  v_cvt_pk_bf16_f32 v30, v30, v30
  v_and_b32 v30, 0xffff0000, v30
  v_sqrt_f32 v30, v30
  v_lshlrev_b32 v32, 16, v26
  v_and_b32 v33, 0xffff0000, v26
  v_cvt_pk_bf16_f32 v30, v30, v30
  v_and_b32 v30, 0xffff0000, v30
  v_rcp_f32 v30, v30
  v_sub_f32 v32, v32, v28
  v_sub_f32 v33, v33, v28
  v_cvt_pk_bf16_f32 v26, v32, v33
  s_cbranch_execz L_wret
  v_lshlrev_b32 v32, 16, v26
  v_and_b32 v33, 0xffff0000, v26
  v_mul_f32 v32, v32, v30
  v_mul_f32 v33, v33, v30
  v_cvt_pk_bf16_f32 v26, v32, v33
  s_nop 1
  v_mov_b32_dpp v18, v26 row_newbcast:0 row_mask:0xf bank_mask:0x3
  v_mov_b32_dpp v18, v26 row_newbcast:8 row_mask:0xf bank_mask:0xc
  v_mov_b32_dpp v19, v26 row_newbcast:1 row_mask:0xf bank_mask:0x3
  v_mov_b32_dpp v19, v26 row_newbcast:9 row_mask:0xf bank_mask:0xc
  v_mov_b32_dpp v20, v26 row_newbcast:2 row_mask:0xf bank_mask:0x3
  v_mov_b32_dpp v20, v26 row_newbcast:10 row_mask:0xf bank_mask:0xc
  v_mov_b32_dpp v21, v26 row_newbcast:3 row_mask:0xf bank_mask:0x3
  v_mov_b32_dpp v21, v26 row_newbcast:11 row_mask:0xf bank_mask:0xc
  v_mov_b32_dpp v22, v26 row_newbcast:4 row_mask:0xf bank_mask:0x3
  v_mov_b32_dpp v22, v26 row_newbcast:12 row_mask:0xf bank_mask:0xc
  v_mov_b32_dpp v23, v26 row_newbcast:5 row_mask:0xf bank_mask:0x3
  s_nop 0
  s_cbranch_execz L_wret
  v_mov_b32_dpp v23, v26 row_newbcast:13 row_mask:0xf bank_mask:0xc
  v_mov_b32_dpp v24, v26 row_newbcast:6 row_mask:0xf bank_mask:0x3
  v_mov_b32_dpp v24, v26 row_newbcast:14 row_mask:0xf bank_mask:0xc
  v_mov_b32_dpp v25, v26 row_newbcast:7 row_mask:0xf bank_mask:0x3
  v_mov_b32_dpp v25, v26 row_newbcast:15 row_mask:0xf bank_mask:0xc
  v_perm_b32 v32, v18, v18, v10
  v_perm_b32 v33, v18, v18, v11
  v_perm_b32 v34, v18, v18, v12
  v_perm_b32 v35, v18, v18, v13
  v_perm_b32 v36, v18, v18, v14
  v_perm_b32 v37, v18, v18, v15
  v_perm_b32 v38, v18, v18, v16
  v_perm_b32 v39, v18, v18, v17
  s_waitcnt vmcnt(15)
  v_mfma_f32_16x16x32_bf16 v[160:163], v[32:35], v[96:99], 0
  v_perm_b32 v40, v19, v19, v10
  s_cbranch_execz L_wret
  v_perm_b32 v41, v19, v19, v11
  v_perm_b32 v42, v19, v19, v12
  v_perm_b32 v43, v19, v19, v13
  s_waitcnt vmcnt(14)
  v_mfma_f32_16x16x32_bf16 v[160:163], v[36:39], v[100:103], v[160:163]
  v_perm_b32 v44, v19, v19, v14
  v_perm_b32 v45, v19, v19, v15
  v_perm_b32 v46, v19, v19, v16
  v_perm_b32 v47, v19, v19, v17
  s_waitcnt vmcnt(13)
  v_mfma_f32_16x16x32_bf16 v[160:163], v[40:43], v[104:107], v[160:163]
  v_perm_b32 v48, v20, v20, v10
  v_perm_b32 v49, v20, v20, v11
  v_perm_b32 v50, v20, v20, v12
  v_perm_b32 v51, v20, v20, v13
  s_waitcnt vmcnt(12)
  v_mfma_f32_16x16x32_bf16 v[160:163], v[44:47], v[108:111], v[160:163]
  s_cbranch_execz L_wret
  v_perm_b32 v52, v20, v20, v14
  v_perm_b32 v53, v20, v20, v15
  v_perm_b32 v54, v20, v20, v16
  v_perm_b32 v55, v20, v20, v17
  s_waitcnt vmcnt(11)
  v_mfma_f32_16x16x32_bf16 v[160:163], v[48:51], v[112:115], v[160:163]
  v_perm_b32 v56, v21, v21, v10
  v_perm_b32 v57, v21, v21, v11
  v_perm_b32 v58, v21, v21, v12
  v_perm_b32 v59, v21, v21, v13
  s_waitcnt vmcnt(10)
  v_mfma_f32_16x16x32_bf16 v[160:163], v[52:55], v[116:119], v[160:163]
  v_perm_b32 v60, v21, v21, v14
  v_perm_b32 v61, v21, v21, v15
  v_perm_b32 v62, v21, v21, v16
  v_perm_b32 v63, v21, v21, v17
  s_waitcnt vmcnt(9)
  s_cbranch_execz L_wret
  v_mfma_f32_16x16x32_bf16 v[160:163], v[56:59], v[120:123], v[160:163]
  v_perm_b32 v64, v22, v22, v10
  v_perm_b32 v65, v22, v22, v11
  v_perm_b32 v66, v22, v22, v12
  v_perm_b32 v67, v22, v22, v13
  s_waitcnt vmcnt(8)
  v_mfma_f32_16x16x32_bf16 v[160:163], v[60:63], v[124:127], v[160:163]
  v_perm_b32 v68, v22, v22, v14
  v_perm_b32 v69, v22, v22, v15
  v_perm_b32 v70, v22, v22, v16
  v_perm_b32 v71, v22, v22, v17
  s_waitcnt vmcnt(7)
  v_mfma_f32_16x16x32_bf16 v[160:163], v[64:67], v[128:131], v[160:163]
  v_perm_b32 v72, v23, v23, v10
  v_perm_b32 v73, v23, v23, v11
  v_perm_b32 v74, v23, v23, v12
  s_nop 0
  s_cbranch_execz L_wret
  v_perm_b32 v75, v23, v23, v13
  s_waitcnt vmcnt(6)
  v_mfma_f32_16x16x32_bf16 v[160:163], v[68:71], v[132:135], v[160:163]
  v_perm_b32 v76, v23, v23, v14
  v_perm_b32 v77, v23, v23, v15
  v_perm_b32 v78, v23, v23, v16
  v_perm_b32 v79, v23, v23, v17
  s_waitcnt vmcnt(5)
  v_mfma_f32_16x16x32_bf16 v[160:163], v[72:75], v[136:139], v[160:163]
  v_perm_b32 v80, v24, v24, v10
  v_perm_b32 v81, v24, v24, v11
  v_perm_b32 v82, v24, v24, v12
  v_perm_b32 v83, v24, v24, v13
  s_waitcnt vmcnt(4)
  v_mfma_f32_16x16x32_bf16 v[160:163], v[76:79], v[140:143], v[160:163]
  v_perm_b32 v84, v24, v24, v14
  v_perm_b32 v85, v24, v24, v15
  s_cbranch_execz L_wret
  v_perm_b32 v86, v24, v24, v16
  v_perm_b32 v87, v24, v24, v17
  s_waitcnt vmcnt(3)
  v_mfma_f32_16x16x32_bf16 v[160:163], v[80:83], v[144:147], v[160:163]
  v_perm_b32 v88, v25, v25, v10
  v_perm_b32 v89, v25, v25, v11
  v_perm_b32 v90, v25, v25, v12
  v_perm_b32 v91, v25, v25, v13
  s_waitcnt vmcnt(2)
  v_mfma_f32_16x16x32_bf16 v[160:163], v[84:87], v[148:151], v[160:163]
  v_perm_b32 v92, v25, v25, v14
  v_perm_b32 v93, v25, v25, v15
  v_perm_b32 v94, v25, v25, v16
  v_perm_b32 v95, v25, v25, v17
  s_waitcnt vmcnt(1)
  v_mfma_f32_16x16x32_bf16 v[160:163], v[88:91], v[152:155], v[160:163]
  s_waitcnt vmcnt(0)
  s_nop 0
  s_cbranch_execz L_wret
  v_mfma_f32_16x16x32_bf16 v[160:163], v[92:95], v[156:159], v[160:163]
  s_waitcnt lgkmcnt(0)
  s_mul_i32 s31, s31, 1664525
  s_add_u32 s31, s31, 1013904223
  v_and_b32 v7, 1, v3
  v_lshlrev_b32 v7, 4, v7
  v_lshl_add_u32 v7, v2, 5, v7
  v_lshrrev_b32 v8, 1, v3
  v_lshl_add_u32 v7, v8, 9, v7
  s_lshl_b32 s56, s30, 18
  s_lshl_b32 s57, s35, 10
  s_add_u32 s56, s56, s57
  s_add_u32 s56, s56, 65536
  s_and_b32 s57, s31, 15
  s_bfe_u32 s92, s59, 0x10000
  s_lshl_b32 s92, s92, 4
  s_or_b32 s92, s92, s57
  s_bfe_u32 s93, s59, 0x10001
  s_lshl_b32 s93, s93, 4
  s_or_b32 s93, s93, s57
  s_bfe_u32 s94, s59, 0x10002
  s_lshl_b32 s94, s94, 4
  s_cbranch_execz L_wret
  s_or_b32 s94, s94, s57
  v_bfi_b32 v160, 31, s92, v160
  v_bfi_b32 v161, 31, s93, v161
  v_bfi_b32 v162, 31, s94, v162
  v_bfi_b32 v163, 15, s31, v163
  s_cmp_eq_u32 s30, 1
  s_cbranch_scc1 L_PG
  s_add_u32 s57, s56, 1245184
  buffer_store_dwordx4 v[160:163], v7, s[36:39], s57 offen
  buffer_store_dwordx4 v[160:163], v7, s[36:39], s56 offen sc1
L_PQ_tail:
  v_lshrrev_b32 v6, 5, v1
  v_and_b32 v8, 31, v1
  v_lshlrev_b32 v9, 3, v8
  v_lshl_add_u32 v9, v6, 2, v9
  v_lshlrev_b32 v6, 12, v6
  v_lshl_add_u32 v6, v8, 4, v6
  s_lshl_b32 s56, s28, 13
  s_lshl_b32 s57, s32, 9
  s_add_u32 s56, s56, s57
  s_add_u32 s56, s56, 65536
  s_nop 0
  s_cbranch_execz L_wret
  s_add_u32 s57, s56, 1245184
L_ks_13:
  s_sleep 1
  ds_read_b128 v[28:31], v4 offset:368
  s_sub_u32 s34, s34, 1
  s_waitcnt lgkmcnt(0)
  s_cbranch_scc1 L_end
  v_min3_i32 v28, v28, v29, v30
  v_min_i32 v28, v28, v31
  v_cmp_gt_i32 vcc, 1, v28
  s_cbranch_vccnz L_ks_13
  buffer_load_dwordx4 v[48:51], v6, s[36:39], s57 offen offset:0 sc1
  buffer_load_dwordx4 v[52:55], v6, s[36:39], s57 offen offset:1024 sc1
  buffer_load_dwordx4 v[56:59], v6, s[36:39], s57 offen offset:2048 sc1
  buffer_load_dwordx4 v[60:63], v6, s[36:39], s57 offen offset:3072 sc1
L_ks_14:
  s_sleep 1
  ds_read_b128 v[28:31], v4 offset:368
  s_sub_u32 s34, s34, 1
  s_waitcnt lgkmcnt(0)
  s_cbranch_scc1 L_end
  v_min3_i32 v28, v28, v29, v30
  v_min_i32 v28, v28, v31
  v_cmp_gt_i32 vcc, 3, v28
  s_cbranch_execz L_wret
  s_cbranch_vccnz L_ks_14
  buffer_load_dwordx4 v[64:67], v6, s[36:39], s57 offen offset:0 sc1
  buffer_load_dwordx4 v[68:71], v6, s[36:39], s57 offen offset:1024 sc1
  buffer_load_dwordx4 v[72:75], v6, s[36:39], s57 offen offset:2048 sc1
  buffer_load_dwordx4 v[76:79], v6, s[36:39], s57 offen offset:3072 sc1
  s_waitcnt vmcnt(4)
  v_xor_b32 v27, s31, v48
  v_bitop3_b32 v27, v27, v49, s31 bitop3:0xf6
  v_bitop3_b32 v27, v27, v50, s31 bitop3:0xf6
  v_bitop3_b32 v27, v27, v51, s31 bitop3:0xf6
  v_bitop3_b32 v27, v27, v52, s31 bitop3:0xf6
  v_bitop3_b32 v27, v27, v53, s31 bitop3:0xf6
  v_bitop3_b32 v27, v27, v54, s31 bitop3:0xf6
  v_bitop3_b32 v27, v27, v55, s31 bitop3:0xf6
  v_bitop3_b32 v27, v27, v56, s31 bitop3:0xf6
  v_bitop3_b32 v27, v27, v57, s31 bitop3:0xf6
  v_bitop3_b32 v27, v27, v58, s31 bitop3:0xf6
  s_cbranch_execz L_wret
  v_bitop3_b32 v27, v27, v59, s31 bitop3:0xf6
  v_bitop3_b32 v27, v27, v60, s31 bitop3:0xf6
  v_bitop3_b32 v27, v27, v61, s31 bitop3:0xf6
  v_bitop3_b32 v27, v27, v62, s31 bitop3:0xf6
  v_bitop3_b32 v27, v27, v63, s31 bitop3:0xf6
  v_and_b32 v27, 15, v27
  v_cmp_ne_u32 vcc, 0, v27
  s_cbranch_vccnz L_qn_15
  v_xor_b32 v28, s92, v48
  v_bitop3_b32 v28, v28, v49, s93 bitop3:0xf6
  v_bitop3_b32 v28, v28, v50, s94 bitop3:0xf6
  v_bitop3_b32 v28, v28, v52, s92 bitop3:0xf6
  v_bitop3_b32 v28, v28, v53, s93 bitop3:0xf6
  v_bitop3_b32 v28, v28, v54, s94 bitop3:0xf6
  v_bitop3_b32 v28, v28, v56, s92 bitop3:0xf6
  v_bitop3_b32 v28, v28, v57, s93 bitop3:0xf6
  v_bitop3_b32 v28, v28, v58, s94 bitop3:0xf6
  s_nop 0
  s_cbranch_execz L_wret
  v_bitop3_b32 v28, v28, v60, s92 bitop3:0xf6
  v_bitop3_b32 v28, v28, v61, s93 bitop3:0xf6
  v_bitop3_b32 v28, v28, v62, s94 bitop3:0xf6
  v_pk_add_f32 v[32:33], v[48:49], v[52:53]
  v_pk_add_f32 v[34:35], v[50:51], v[54:55]
  v_pk_add_f32 v[40:41], v[56:57], v[60:61]
  v_pk_add_f32 v[42:43], v[58:59], v[62:63]
  s_branch L_q_ok
L_qn_15:
  s_waitcnt vmcnt(0)
  v_xor_b32 v27, s31, v64
  v_bitop3_b32 v27, v27, v65, s31 bitop3:0xf6
  v_bitop3_b32 v27, v27, v66, s31 bitop3:0xf6
  v_bitop3_b32 v27, v27, v67, s31 bitop3:0xf6
  v_bitop3_b32 v27, v27, v68, s31 bitop3:0xf6
  v_bitop3_b32 v27, v27, v69, s31 bitop3:0xf6
  v_bitop3_b32 v27, v27, v70, s31 bitop3:0xf6
  v_bitop3_b32 v27, v27, v71, s31 bitop3:0xf6
  s_cbranch_execz L_wret
  v_bitop3_b32 v27, v27, v72, s31 bitop3:0xf6
  v_bitop3_b32 v27, v27, v73, s31 bitop3:0xf6
  v_bitop3_b32 v27, v27, v74, s31 bitop3:0xf6
  v_bitop3_b32 v27, v27, v75, s31 bitop3:0xf6
  v_bitop3_b32 v27, v27, v76, s31 bitop3:0xf6
  v_bitop3_b32 v27, v27, v77, s31 bitop3:0xf6
  v_bitop3_b32 v27, v27, v78, s31 bitop3:0xf6
  v_bitop3_b32 v27, v27, v79, s31 bitop3:0xf6
  v_and_b32 v27, 15, v27
  v_cmp_ne_u32 vcc, 0, v27
  s_cbranch_vccnz L_qn_16
  v_xor_b32 v28, s92, v64
  v_bitop3_b32 v28, v28, v65, s93 bitop3:0xf6
  v_bitop3_b32 v28, v28, v66, s94 bitop3:0xf6
  v_bitop3_b32 v28, v28, v68, s92 bitop3:0xf6
  v_bitop3_b32 v28, v28, v69, s93 bitop3:0xf6
  v_bitop3_b32 v28, v28, v70, s94 bitop3:0xf6
  s_nop 0
  s_cbranch_execz L_wret
  v_bitop3_b32 v28, v28, v72, s92 bitop3:0xf6
  v_bitop3_b32 v28, v28, v73, s93 bitop3:0xf6
  v_bitop3_b32 v28, v28, v74, s94 bitop3:0xf6
  v_bitop3_b32 v28, v28, v76, s92 bitop3:0xf6
  v_bitop3_b32 v28, v28, v77, s93 bitop3:0xf6
  v_bitop3_b32 v28, v28, v78, s94 bitop3:0xf6
  v_pk_add_f32 v[32:33], v[64:65], v[68:69]
  v_pk_add_f32 v[34:35], v[66:67], v[70:71]
  v_pk_add_f32 v[40:41], v[72:73], v[76:77]
  v_pk_add_f32 v[42:43], v[74:75], v[78:79]
  s_branch L_q_ok
L_qn_16:
L_poll_17:
  buffer_load_dwordx4 v[32:35], v6, s[36:39], s56 offen offset:0 sc1
  buffer_load_dwordx4 v[36:39], v6, s[36:39], s56 offen offset:1024 sc1
  buffer_load_dwordx4 v[40:43], v6, s[36:39], s56 offen offset:2048 sc1
  buffer_load_dwordx4 v[44:47], v6, s[36:39], s56 offen offset:3072 sc1
  s_sub_u32 s34, s34, 64
  s_waitcnt vmcnt(0)
  s_cbranch_execz L_wret
  s_cbranch_scc1 L_end
  v_xor_b32 v27, s31, v32
  v_bitop3_b32 v27, v27, v33, s31 bitop3:0xf6
  v_bitop3_b32 v27, v27, v34, s31 bitop3:0xf6
  v_bitop3_b32 v27, v27, v35, s31 bitop3:0xf6
  v_bitop3_b32 v27, v27, v36, s31 bitop3:0xf6
  v_bitop3_b32 v27, v27, v37, s31 bitop3:0xf6
  v_bitop3_b32 v27, v27, v38, s31 bitop3:0xf6
  v_bitop3_b32 v27, v27, v39, s31 bitop3:0xf6
  v_bitop3_b32 v27, v27, v40, s31 bitop3:0xf6
  v_bitop3_b32 v27, v27, v41, s31 bitop3:0xf6
  v_bitop3_b32 v27, v27, v42, s31 bitop3:0xf6
  v_bitop3_b32 v27, v27, v43, s31 bitop3:0xf6
  v_bitop3_b32 v27, v27, v44, s31 bitop3:0xf6
  v_bitop3_b32 v27, v27, v45, s31 bitop3:0xf6
  v_bitop3_b32 v27, v27, v46, s31 bitop3:0xf6
  s_nop 0
  s_cbranch_execz L_wret
  v_bitop3_b32 v27, v27, v47, s31 bitop3:0xf6
  v_and_b32 v27, 15, v27
  v_cmp_ne_u32 vcc, 0, v27
  s_cbranch_vccnz L_poll_17
L_pollo_18:
  v_xor_b32 v28, s92, v32
  v_bitop3_b32 v28, v28, v33, s93 bitop3:0xf6
  v_bitop3_b32 v28, v28, v34, s94 bitop3:0xf6
  v_bitop3_b32 v28, v28, v36, s92 bitop3:0xf6
  v_bitop3_b32 v28, v28, v37, s93 bitop3:0xf6
  v_bitop3_b32 v28, v28, v38, s94 bitop3:0xf6
  v_bitop3_b32 v28, v28, v40, s92 bitop3:0xf6
  v_bitop3_b32 v28, v28, v41, s93 bitop3:0xf6
  v_bitop3_b32 v28, v28, v42, s94 bitop3:0xf6
  v_bitop3_b32 v28, v28, v44, s92 bitop3:0xf6
  v_bitop3_b32 v28, v28, v45, s93 bitop3:0xf6
  v_bitop3_b32 v28, v28, v46, s94 bitop3:0xf6
  v_pk_add_f32 v[32:33], v[32:33], v[36:37]
  s_nop 0
  s_cbranch_execz L_wret
  v_pk_add_f32 v[34:35], v[34:35], v[38:39]
  v_pk_add_f32 v[40:41], v[40:41], v[44:45]
  v_pk_add_f32 v[42:43], v[42:43], v[46:47]
L_q_ok:
  v_pk_add_f32 v[32:33], v[32:33], v[40:41]
  v_pk_add_f32 v[34:35], v[34:35], v[42:43]
  v_and_b32 v28, 31, v28
  v_cmp_ne_u32 vcc, 0, v28
  v_permlane32_swap_b32 v32, v34
  v_permlane32_swap_b32 v33, v35
  v_add_f32 v32, v32, v34
  v_add_f32 v33, v33, v35
  v_cvt_pk_bf16_f32 v32, v32, v33
  s_cmp_eq_u64 vcc, 0
  s_cselect_b32 s58, 1, 0
  ds_write_b32 v9, v32 offset:0
  v_mov_b32 v33, s58
  ds_write_b32 v4, v33 offset:352
  v_and_b32 v6, 7, v1
  v_lshlrev_b32 v9, 2, v6
  v_lshlrev_b32 v6, 7, v6
  s_lshl_b32 s56, s35, 7
  s_add_u32 s56, s56, 589824
  s_cbranch_execz L_wret
  s_lshl_b32 s57, s28, 10
  s_add_u32 s57, s57, 589824
  v_lshlrev_b32 v7, 4, v1
L_spin_19:
  s_sleep 1
  ds_read_b128 v[32:35], v4 offset:272
  s_sub_u32 s34, s34, 1
  s_waitcnt lgkmcnt(0)
  s_cbranch_scc1 L_end
  v_max3_u32 v36, v32, v33, v34
  v_max_u32 v36, v36, v35
  v_cmp_eq_u32 vcc, -1, v36
  s_cbranch_vccnz L_spin_19
L_spino_20:
  ds_read_b128 v[40:43], v4 offset:256
  v_add_f32 v33, v32, v33
  v_add_f32 v34, v34, v35
  v_add_f32 v33, v33, v34
  s_waitcnt lgkmcnt(0)
  v_max3_f32 v32, v40, v41, v42
  v_max_f32 v32, v32, v43
  v_bfi_b32 v32, v5, s31, v32
  v_bfi_b32 v33, v5, s31, v33
  v_mov_b32 v34, v32
  v_mov_b32 v35, v33
  s_nop 0
  s_cbranch_execz L_wret
  s_mov_b64 exec, 0xff
  s_cmp_eq_u32 s58, 1
  s_cbranch_scc1 L_st_fast
  buffer_store_dwordx4 v[32:35], v7, s[36:39], s56 offen sc1
  s_branch L_st_pub
L_st_fast:
  buffer_store_dwordx4 v[32:35], v7, s[36:39], s56 offen
L_st_pub:
  s_mov_b64 exec, -1
L_poll_21:
  buffer_load_dwordx4 v[36:39], v6, s[36:39], s57 offen sc1
  s_sub_u32 s34, s34, 64
  s_waitcnt vmcnt(0)
  s_cbranch_scc1 L_end
  v_xor_b32 v27, s31, v36
  v_bitop3_b32 v27, v27, v37, s31 bitop3:0xf6
  v_bitop3_b32 v27, v27, v38, s31 bitop3:0xf6
  v_bitop3_b32 v27, v27, v39, s31 bitop3:0xf6
  v_and_b32 v27, v5, v27
  v_cmp_ne_u32 vcc, 0, v27
  s_cbranch_vccnz L_poll_21
L_pollo_22:
  v_and_b32 v36, 0xffffff00, v36
  s_nop 1
  v_max_f32_dpp v40, v36, v36 quad_perm:[1,0,3,2] row_mask:0xf bank_mask:0xf
  s_nop 1
  s_cbranch_execz L_wret
  v_max_f32_dpp v40, v40, v40 quad_perm:[2,3,0,1] row_mask:0xf bank_mask:0xf
  v_sub_f32 v36, v36, v40
  v_mul_f32 v36, 0x3fb8aa3b, v36
  v_exp_f32 v36, v36
  s_nop 0
  v_mul_f32 v37, v36, v37
  s_nop 1
  v_add_f32_dpp v37, v37, v37 quad_perm:[1,0,3,2] row_mask:0xf bank_mask:0xf
  s_nop 1
  v_add_f32_dpp v37, v37, v37 quad_perm:[2,3,0,1] row_mask:0xf bank_mask:0xf
  v_rcp_f32 v37, v37
  s_nop 0
  v_mul_f32 v36, v36, v37
  ds_write_b32 v9, v36 offset:288
  s_endpgm
L_PG:
  buffer_store_dwordx4 v[160:163], v7, s[36:39], s56 offen sc1
  s_mov_b32 s40, s20
  s_mov_b32 s41, s21
  s_mov_b32 s42, 0x158000
  s_mov_b32 s43, 0x20000
  s_lshl_b32 s58, s90, 11
  v_mul_lo_u32 v6, v3, s58
  s_cbranch_execz L_wret
  v_lshl_add_u32 v6, v2, 4, v6
  s_and_b32 s57, s28, 1
  s_lshl_b32 s57, s57, 1
  s_add_u32 s57, s57, s32
  s_mul_i32 s57, s57, s90
  s_lshl_b32 s52, s91, 2
  s_add_u32 s52, s52, s57
  s_lshl_b32 s52, s52, 13
  s_lshl_b32 s53, s33, 8
  s_add_u32 s52, s52, s53
  s_add_u32 s53, s52, 0x1000
  buffer_load_dwordx4 v[96:99], v6, s[40:43], s52 offen offset:0 nt
  buffer_load_dwordx4 v[100:103], v6, s[40:43], s52 offen offset:1024 nt
  s_cmp_le_u32 s90, 1
  s_cbranch_scc1 L_wde_23
  buffer_load_dwordx4 v[104:107], v6, s[40:43], s52 offen offset:2048 nt
  buffer_load_dwordx4 v[108:111], v6, s[40:43], s52 offen offset:3072 nt
  s_cmp_le_u32 s90, 2
  s_cbranch_scc1 L_wde_23
  buffer_load_dwordx4 v[112:115], v6, s[40:43], s53 offen offset:0 nt
  buffer_load_dwordx4 v[116:119], v6, s[40:43], s53 offen offset:1024 nt
  s_cmp_le_u32 s90, 3
  s_cbranch_scc1 L_wde_23
  s_cbranch_execz L_wret
  buffer_load_dwordx4 v[120:123], v6, s[40:43], s53 offen offset:2048 nt
  buffer_load_dwordx4 v[124:127], v6, s[40:43], s53 offen offset:3072 nt
L_wde_23:
  s_and_b32 s63, s2, 31
  s_lshl_b32 s54, s63, 13
  s_add_u32 s54, s54, 1048576
  s_lshr_b32 s55, s63, 3
  s_lshl_b32 s55, s55, 8
  s_lshl_b32 s63, s63, 7
  s_bfe_u32 s62, s63, 0x10009
  s_lshl_b32 s62, s62, 10
  s_add_u32 s55, s55, s62
  s_and_b32 s63, s63, 511
  s_lshr_b32 s63, s63, 1
  s_add_u32 s55, s55, s63
  v_and_b32 v165, 7, v1
  v_lshlrev_b32 v165, 3, v165
  v_lshl_add_u32 v165, v3, 1, v165
  v_lshlrev_b32 v9, 4, v1
  buffer_load_ushort v164, v165, s[44:47], s55 offen
  s_mov_b32 s48, s22
  s_mov_b32 s49, s23
  s_mov_b32 s50, 0x800
  s_nop 0
  s_cbranch_execz L_wret
  s_mov_b32 s51, 0x20000
  v_lshrrev_b32 v7, 3, v2
  v_lshlrev_b32 v7, 9, v7
  v_and_b32 v27, 7, v2
  s_sub_u32 s56, s90, 1
  v_min_u32 v27, s56, v27
  v_lshl_add_u32 v7, v27, 3, v7
  s_lshl_b32 s56, s90, 3
  v_mad_u32_u24 v7, v3, s56, v7
  s_and_b32 s56, s28, 30
  s_lshl_b32 s56, s56, 13
  s_lshl_b32 s57, s57, 5
  s_add_u32 s56, s56, s57
  s_add_u32 s60, s56, 327680
  s_add_u32 s61, s56, 331776
  s_add_u32 s62, s56, 335872
  s_add_u32 s63, s56, 339968
L_PG_tail:
L_ks_24:
  s_sleep 1
  ds_read_b128 v[28:31], v4 offset:368
  s_sub_u32 s34, s34, 1
  s_waitcnt lgkmcnt(0)
  s_cbranch_scc1 L_end
  s_nop 0
  s_cbranch_execz L_wret
  v_min3_i32 v28, v28, v29, v30
  v_min_i32 v28, v28, v31
  v_cmp_gt_i32 vcc, 3, v28
  s_cbranch_vccnz L_ks_24
L_poll_25:
  buffer_load_dwordx2 v[128:129], v7, s[36:39], s60 offen offset:0 sc1
  buffer_load_dwordx2 v[130:131], v7, s[36:39], s60 offen offset:1024 sc1
  buffer_load_dwordx2 v[132:133], v7, s[36:39], s60 offen offset:2048 sc1
  buffer_load_dwordx2 v[134:135], v7, s[36:39], s60 offen offset:3072 sc1
  buffer_load_dwordx2 v[136:137], v7, s[36:39], s61 offen offset:0 sc1
  buffer_load_dwordx2 v[138:139], v7, s[36:39], s61 offen offset:1024 sc1
  buffer_load_dwordx2 v[140:141], v7, s[36:39], s61 offen offset:2048 sc1
  buffer_load_dwordx2 v[142:143], v7, s[36:39], s61 offen offset:3072 sc1
  buffer_load_dwordx2 v[144:145], v7, s[36:39], s62 offen offset:0 sc1
  buffer_load_dwordx2 v[146:147], v7, s[36:39], s62 offen offset:1024 sc1
  buffer_load_dwordx2 v[148:149], v7, s[36:39], s62 offen offset:2048 sc1
  buffer_load_dwordx2 v[150:151], v7, s[36:39], s62 offen offset:3072 sc1
  buffer_load_dwordx2 v[152:153], v7, s[36:39], s63 offen offset:0 sc1
  s_cbranch_execz L_wret
  buffer_load_dwordx2 v[154:155], v7, s[36:39], s63 offen offset:1024 sc1
  buffer_load_dwordx2 v[156:157], v7, s[36:39], s63 offen offset:2048 sc1
  buffer_load_dwordx2 v[158:159], v7, s[36:39], s63 offen offset:3072 sc1
  s_sub_u32 s34, s34, 64
  s_waitcnt vmcnt(0)
  s_cbranch_scc1 L_end
  v_xor_b32 v27, s31, v128
  v_bitop3_b32 v27, v27, v129, s31 bitop3:0xf6
  v_bitop3_b32 v27, v27, v130, s31 bitop3:0xf6
  v_bitop3_b32 v27, v27, v131, s31 bitop3:0xf6
  v_bitop3_b32 v27, v27, v132, s31 bitop3:0xf6
  v_bitop3_b32 v27, v27, v133, s31 bitop3:0xf6
  v_bitop3_b32 v27, v27, v134, s31 bitop3:0xf6
  v_bitop3_b32 v27, v27, v135, s31 bitop3:0xf6
  v_bitop3_b32 v27, v27, v136, s31 bitop3:0xf6
  v_bitop3_b32 v27, v27, v137, s31 bitop3:0xf6
  v_bitop3_b32 v27, v27, v138, s31 bitop3:0xf6
  s_nop 0
  s_cbranch_execz L_wret
  v_bitop3_b32 v27, v27, v139, s31 bitop3:0xf6
  v_bitop3_b32 v27, v27, v140, s31 bitop3:0xf6
  v_bitop3_b32 v27, v27, v141, s31 bitop3:0xf6
  v_bitop3_b32 v27, v27, v142, s31 bitop3:0xf6
  v_bitop3_b32 v27, v27, v143, s31 bitop3:0xf6
  v_bitop3_b32 v27, v27, v144, s31 bitop3:0xf6
  v_bitop3_b32 v27, v27, v145, s31 bitop3:0xf6
  v_bitop3_b32 v27, v27, v146, s31 bitop3:0xf6
  v_bitop3_b32 v27, v27, v147, s31 bitop3:0xf6
  v_bitop3_b32 v27, v27, v148, s31 bitop3:0xf6
  v_bitop3_b32 v27, v27, v149, s31 bitop3:0xf6
  v_bitop3_b32 v27, v27, v150, s31 bitop3:0xf6
  v_bitop3_b32 v27, v27, v151, s31 bitop3:0xf6
  v_bitop3_b32 v27, v27, v152, s31 bitop3:0xf6
  v_bitop3_b32 v27, v27, v153, s31 bitop3:0xf6
  s_nop 0
  s_cbranch_execz L_wret
  v_bitop3_b32 v27, v27, v154, s31 bitop3:0xf6
  v_bitop3_b32 v27, v27, v155, s31 bitop3:0xf6
  v_bitop3_b32 v27, v27, v156, s31 bitop3:0xf6
  v_bitop3_b32 v27, v27, v157, s31 bitop3:0xf6
  v_bitop3_b32 v27, v27, v158, s31 bitop3:0xf6
  v_bitop3_b32 v27, v27, v159, s31 bitop3:0xf6
  v_and_b32 v27, 15, v27
  v_cmp_ne_u32 vcc, 0, v27
  s_cbranch_vccnz L_poll_25
L_pollo_26:
  v_pk_add_f32 v[128:129], v[128:129], v[136:137]
  v_pk_add_f32 v[130:131], v[130:131], v[138:139]
  v_pk_add_f32 v[132:133], v[132:133], v[140:141]
  v_pk_add_f32 v[134:135], v[134:135], v[142:143]
  v_pk_add_f32 v[128:129], v[128:129], v[132:133]
  v_pk_add_f32 v[130:131], v[130:131], v[134:135]
  v_pk_add_f32 v[128:129], v[128:129], v[130:131]
  v_pk_add_f32 v[144:145], v[144:145], v[152:153]
  s_cbranch_execz L_wret
  v_pk_add_f32 v[146:147], v[146:147], v[154:155]
  v_pk_add_f32 v[148:149], v[148:149], v[156:157]
  v_pk_add_f32 v[150:151], v[150:151], v[158:159]
  v_pk_add_f32 v[144:145], v[144:145], v[148:149]
  v_pk_add_f32 v[146:147], v[146:147], v[150:151]
  v_pk_add_f32 v[144:145], v[144:145], v[146:147]
  v_cvt_pk_bf16_f32 v28, v128, v129
  v_cvt_pk_bf16_f32 v29, v144, v145
  v_lshlrev_b32 v30, 16, v28
  v_and_b32 v31, 0xffff0000, v28
  v_mul_f32 v30, 0xbfb8aa3b, v30
  v_mul_f32 v31, 0xbfb8aa3b, v31
  v_exp_f32 v30, v30
  v_exp_f32 v31, v31
  v_add_f32 v30, 1.0, v30
  v_add_f32 v31, 1.0, v31
  v_rcp_f32 v30, v30
  v_rcp_f32 v31, v31
  v_lshlrev_b32 v32, 16, v29
  s_nop 0
  s_cbranch_execz L_wret
  v_and_b32 v33, 0xffff0000, v29
  v_cvt_pk_bf16_f32 v28, v30, v31
  v_lshlrev_b32 v30, 16, v28
  v_and_b32 v31, 0xffff0000, v28
  v_mul_f32 v30, v30, v32
  v_mul_f32 v31, v31, v33
  v_cvt_pk_bf16_f32 v26, v30, v31
  s_nop 1
  v_mov_b32_dpp v18, v26 row_newbcast:0 row_mask:0xf bank_mask:0x3
  v_mov_b32_dpp v18, v26 row_newbcast:8 row_mask:0xf bank_mask:0xc
  v_mov_b32_dpp v19, v26 row_newbcast:1 row_mask:0xf bank_mask:0x3
  v_mov_b32_dpp v19, v26 row_newbcast:9 row_mask:0xf bank_mask:0xc
  v_mov_b32_dpp v20, v26 row_newbcast:2 row_mask:0xf bank_mask:0x3
  v_mov_b32_dpp v20, v26 row_newbcast:10 row_mask:0xf bank_mask:0xc
  v_mov_b32_dpp v21, v26 row_newbcast:3 row_mask:0xf bank_mask:0x3
  v_mov_b32_dpp v21, v26 row_newbcast:11 row_mask:0xf bank_mask:0xc
  v_perm_b32 v32, v18, v18, v10
  s_nop 0
  s_cbranch_execz L_wret
  v_perm_b32 v33, v18, v18, v11
  v_perm_b32 v34, v18, v18, v12
  v_perm_b32 v35, v18, v18, v13
  v_perm_b32 v36, v18, v18, v14
  v_perm_b32 v37, v18, v18, v15
  v_perm_b32 v38, v18, v18, v16
  v_perm_b32 v39, v18, v18, v17
  v_mfma_f32_16x16x32_bf16 v[160:163], v[32:35], v[96:99], 0
  s_nop 0
  v_mfma_f32_16x16x32_bf16 v[160:163], v[36:39], v[100:103], v[160:163]
  s_cmp_le_u32 s90, 1
  s_cbranch_scc1 L_wd_done
  v_perm_b32 v40, v19, v19, v10
  v_perm_b32 v41, v19, v19, v11
  v_perm_b32 v42, v19, v19, v12
  v_perm_b32 v43, v19, v19, v13
  v_perm_b32 v44, v19, v19, v14
  s_cbranch_execz L_wret
  v_perm_b32 v45, v19, v19, v15
  v_perm_b32 v46, v19, v19, v16
  v_perm_b32 v47, v19, v19, v17
  v_mfma_f32_16x16x32_bf16 v[160:163], v[40:43], v[104:107], v[160:163]
  s_nop 0
  v_mfma_f32_16x16x32_bf16 v[160:163], v[44:47], v[108:111], v[160:163]
  s_cmp_le_u32 s90, 2
  s_cbranch_scc1 L_wd_done
  v_perm_b32 v48, v20, v20, v10
  v_perm_b32 v49, v20, v20, v11
  v_perm_b32 v50, v20, v20, v12
  v_perm_b32 v51, v20, v20, v13
  v_perm_b32 v52, v20, v20, v14
  v_perm_b32 v53, v20, v20, v15
  v_perm_b32 v54, v20, v20, v16
  v_perm_b32 v55, v20, v20, v17
  v_mfma_f32_16x16x32_bf16 v[160:163], v[48:51], v[112:115], v[160:163]
  s_cbranch_execz L_wret
  s_nop 0
  v_mfma_f32_16x16x32_bf16 v[160:163], v[52:55], v[116:119], v[160:163]
  s_cmp_le_u32 s90, 3
  s_cbranch_scc1 L_wd_done
  v_perm_b32 v56, v21, v21, v10
  v_perm_b32 v57, v21, v21, v11
  v_perm_b32 v58, v21, v21, v12
  v_perm_b32 v59, v21, v21, v13
  v_perm_b32 v60, v21, v21, v14
  v_perm_b32 v61, v21, v21, v15
  v_perm_b32 v62, v21, v21, v16
  v_perm_b32 v63, v21, v21, v17
  v_mfma_f32_16x16x32_bf16 v[160:163], v[56:59], v[120:123], v[160:163]
  s_nop 0
  v_mfma_f32_16x16x32_bf16 v[160:163], v[60:63], v[124:127], v[160:163]
L_wd_done:
  s_nop 7
  v_lshlrev_b32 v164, 16, v164
  ds_write_b128 v9, v[160:163] offset:3584
  s_nop 0
  s_cbranch_execz L_wret
  ds_write_b32 v4, v4 offset:320
  s_cmp_lt_u32 s2, 32
  s_cbranch_scc0 L_f_end
L_Ffin:
L_spin_27:
  s_sleep 1
  ds_read_b32 v27, v4 offset:384
  s_sub_u32 s34, s34, 1
  s_waitcnt lgkmcnt(0)
  s_cbranch_scc1 L_end
  v_cmp_eq_u32 vcc, -1, v27
  s_cbranch_vccnz L_spin_27
L_spino_28:
  s_add_u32 s53, s54, 0x1000
L_poll_29:
  buffer_load_dwordx4 v[32:35], v9, s[36:39], s54 offen offset:0 sc1
  buffer_load_dwordx4 v[36:39], v9, s[36:39], s54 offen offset:1024 sc1
  buffer_load_dwordx4 v[40:43], v9, s[36:39], s54 offen offset:2048 sc1
  buffer_load_dwordx4 v[44:47], v9, s[36:39], s54 offen offset:3072 sc1
  buffer_load_dwordx4 v[48:51], v9, s[36:39], s53 offen offset:0 sc1
  buffer_load_dwordx4 v[52:55], v9, s[36:39], s53 offen offset:1024 sc1
  buffer_load_dwordx4 v[56:59], v9, s[36:39], s53 offen offset:2048 sc1
  buffer_load_dwordx4 v[60:63], v9, s[36:39], s53 offen offset:3072 sc1
  s_sub_u32 s34, s34, 64
  s_cbranch_execz L_wret
  s_waitcnt vmcnt(0)
  s_cbranch_scc1 L_end
  v_xor_b32 v27, s31, v32
  v_bitop3_b32 v27, v27, v33, s31 bitop3:0xf6
  v_bitop3_b32 v27, v27, v34, s31 bitop3:0xf6
  v_bitop3_b32 v27, v27, v35, s31 bitop3:0xf6
  v_bitop3_b32 v27, v27, v36, s31 bitop3:0xf6
  v_bitop3_b32 v27, v27, v37, s31 bitop3:0xf6
  v_bitop3_b32 v27, v27, v38, s31 bitop3:0xf6
  v_bitop3_b32 v27, v27, v39, s31 bitop3:0xf6
  v_bitop3_b32 v27, v27, v40, s31 bitop3:0xf6
  v_bitop3_b32 v27, v27, v41, s31 bitop3:0xf6
  v_bitop3_b32 v27, v27, v42, s31 bitop3:0xf6
  v_bitop3_b32 v27, v27, v43, s31 bitop3:0xf6
  v_bitop3_b32 v27, v27, v44, s31 bitop3:0xf6
  v_bitop3_b32 v27, v27, v45, s31 bitop3:0xf6
  v_bitop3_b32 v27, v27, v46, s31 bitop3:0xf6
  s_cbranch_execz L_wret
  v_bitop3_b32 v27, v27, v47, s31 bitop3:0xf6
  v_bitop3_b32 v27, v27, v48, s31 bitop3:0xf6
  v_bitop3_b32 v27, v27, v49, s31 bitop3:0xf6
  v_bitop3_b32 v27, v27, v50, s31 bitop3:0xf6
  v_bitop3_b32 v27, v27, v51, s31 bitop3:0xf6
  v_bitop3_b32 v27, v27, v52, s31 bitop3:0xf6
  v_bitop3_b32 v27, v27, v53, s31 bitop3:0xf6
  v_bitop3_b32 v27, v27, v54, s31 bitop3:0xf6
  v_bitop3_b32 v27, v27, v55, s31 bitop3:0xf6
  v_bitop3_b32 v27, v27, v56, s31 bitop3:0xf6
  v_bitop3_b32 v27, v27, v57, s31 bitop3:0xf6
  v_bitop3_b32 v27, v27, v58, s31 bitop3:0xf6
  v_bitop3_b32 v27, v27, v59, s31 bitop3:0xf6
  v_bitop3_b32 v27, v27, v60, s31 bitop3:0xf6
  v_bitop3_b32 v27, v27, v61, s31 bitop3:0xf6
  s_nop 0
  s_cbranch_execz L_wret
  v_bitop3_b32 v27, v27, v62, s31 bitop3:0xf6
  v_bitop3_b32 v27, v27, v63, s31 bitop3:0xf6
  v_and_b32 v27, v5, v27
  v_cmp_ne_u32 vcc, 0, v27
  s_cbranch_vccnz L_poll_29
L_pollo_30:
  v_pk_add_f32 v[32:33], v[32:33], v[48:49]
  v_pk_add_f32 v[34:35], v[34:35], v[50:51]
  v_pk_add_f32 v[36:37], v[36:37], v[52:53]
  v_pk_add_f32 v[38:39], v[38:39], v[54:55]
  v_pk_add_f32 v[40:41], v[40:41], v[56:57]
  v_pk_add_f32 v[42:43], v[42:43], v[58:59]
  v_pk_add_f32 v[44:45], v[44:45], v[60:61]
  v_pk_add_f32 v[46:47], v[46:47], v[62:63]
  v_pk_add_f32 v[32:33], v[32:33], v[40:41]
  v_pk_add_f32 v[34:35], v[34:35], v[42:43]
  v_pk_add_f32 v[36:37], v[36:37], v[44:45]
  v_pk_add_f32 v[38:39], v[38:39], v[46:47]
  s_cbranch_execz L_wret
  v_pk_add_f32 v[32:33], v[32:33], v[36:37]
  v_pk_add_f32 v[34:35], v[34:35], v[38:39]
  s_nop 1
  v_permlane32_swap_b32 v32, v34
  v_permlane32_swap_b32 v33, v35
  v_add_f32 v32, v32, v34
  v_add_f32 v33, v33, v35
  s_nop 1
  v_permlane16_swap_b32 v32, v33
  v_add_f32 v32, v32, v33
  s_nop 1
  v_add_f32_dpp v32, v32, v32 row_ror:8 row_mask:0xf bank_mask:0xf
  v_add_f32 v32, v164, v32
  v_cvt_pk_bf16_f32 v32, v32, v32
  s_mov_b32 exec_lo, 0xff00ff
  s_mov_b32 exec_hi, 0xff00ff
  buffer_store_short v32, v165, s[48:51], s55 offen
  s_cmp_eq_u32 s2, 0
  s_cbranch_scc0 L_fe_31
  s_mov_b64 exec, 1
  v_mov_b32 v33, s31
  buffer_store_dword v33, v4, s[36:39], 0 offen sc1
L_fe_31:
L_f_end:
  s_endpgm
  s_cbranch_execz L_wret
L_S:
  s_sub_u32 s30, s30, 2
  s_lshr_b32 s59, s30, 2
  s_and_b32 s30, s30, 3
  v_lshlrev_b32 v6, 4, v1
  s_lshl_b32 s52, s32, 25
  s_lshl_b32 s53, s28, 20
  s_add_u32 s52, s52, s53
  s_lshl_b32 s53, s33, 16
  s_add_u32 s52, s52, s53
  s_lshl_b32 s53, s30, 14
  s_add_u32 s52, s52, s53
  s_add_u32 s52, s52, 0xC0000
  s_add_u32 s53, s52, 0x1000
  s_add_u32 s54, s52, 0x2000
  s_add_u32 s55, s52, 0x3000
  s_mov_b32 s42, 0x4000000
  s_mov_b32 s43, 0x20000
  s_lshl_b32 s56, s30, 2
  v_mov_b32 v165, s56
  s_lshl_b32 s56, s30, 8
  v_lshl_add_u32 v167, v1, 2, s56
  v_lshlrev_b32 v166, 4, v2
  s_waitcnt lgkmcnt(0)
  s_mov_b32 s40, s6
  s_cbranch_execz L_wret
  s_mov_b32 s41, s7
  s_cmp_eq_u32 s59, 1
  s_barrier
  s_cbranch_scc1 L_V
  buffer_load_dwordx4 v[32:35], v6, s[40:43], s52 offen offset:0 nt
  buffer_load_dwordx4 v[36:39], v6, s[40:43], s52 offen offset:1024 nt
  buffer_load_dwordx4 v[40:43], v6, s[40:43], s52 offen offset:2048 nt
  buffer_load_dwordx4 v[44:47], v6, s[40:43], s52 offen offset:3072 nt
  buffer_load_dwordx4 v[48:51], v6, s[40:43], s53 offen offset:0 nt
  buffer_load_dwordx4 v[52:55], v6, s[40:43], s53 offen offset:1024 nt
  buffer_load_dwordx4 v[56:59], v6, s[40:43], s53 offen offset:2048 nt
  buffer_load_dwordx4 v[60:63], v6, s[40:43], s53 offen offset:3072 nt
  buffer_load_dwordx4 v[64:67], v6, s[40:43], s54 offen offset:0 nt
  buffer_load_dwordx4 v[68:71], v6, s[40:43], s54 offen offset:1024 nt
  s_waitcnt vmcnt(9)
  buffer_load_dwordx4 v[72:75], v6, s[40:43], s54 offen offset:2048 nt
  s_waitcnt vmcnt(9)
  buffer_load_dwordx4 v[76:79], v6, s[40:43], s54 offen offset:3072 nt
  v_mov_b32 v12, 1
  s_cbranch_execz L_wret
  ds_write_b32 v165, v12 offset:368
  s_waitcnt vmcnt(9)
  buffer_load_dwordx4 v[80:83], v6, s[40:43], s55 offen offset:0 nt
  s_waitcnt vmcnt(9)
  buffer_load_dwordx4 v[84:87], v6, s[40:43], s55 offen offset:1024 nt
  v_mov_b32 v12, 2
  ds_write_b32 v165, v12 offset:368
  s_waitcnt vmcnt(9)
  buffer_load_dwordx4 v[88:91], v6, s[40:43], s55 offen offset:2048 nt
  s_waitcnt vmcnt(9)
  buffer_load_dwordx4 v[92:95], v6, s[40:43], s55 offen offset:3072 nt
  v_mov_b32 v12, 3
  ds_write_b32 v165, v12 offset:368
  s_mov_b32 s88, 0xcccccccc
  s_mov_b32 s89, 0xcccccccc
  s_mov_b32 s90, 0xaaaaaaaa
  s_mov_b32 s91, 0xaaaaaaaa
  v_mov_b32 v12, 4
  s_waitcnt vmcnt(8)
  s_nop 0
  s_cbranch_execz L_wret
  ds_write_b32 v165, v12 offset:368
  v_mov_b32 v12, 5
  s_waitcnt vmcnt(6)
  ds_write_b32 v165, v12 offset:368
  v_mov_b32 v12, 6
  s_waitcnt vmcnt(4)
  ds_write_b32 v165, v12 offset:368
  v_mov_b32 v12, 7
  s_waitcnt vmcnt(2)
  ds_write_b32 v165, v12 offset:368
  v_mov_b32 v12, 8
  s_waitcnt vmcnt(0)
  ds_write_b32 v165, v12 offset:368
L_Ksm:
L_spin_2:
  s_sleep 1
  ds_read_b32 v16, v4 offset:352
  s_sub_u32 s34, s34, 1
  s_waitcnt lgkmcnt(0)
  s_cbranch_scc1 L_end
  v_cmp_eq_u32 vcc, -1, v16
  s_cbranch_vccnz L_spin_2
L_spino_3:
  ds_read_b128 v[12:15], v166 offset:0
  s_waitcnt lgkmcnt(0)
  v_dot2_f32_bf16 v16, v32, v12, 0
  s_cbranch_execz L_wret
  v_dot2_f32_bf16 v17, v36, v12, 0
  v_dot2_f32_bf16 v16, v33, v13, v16
  v_dot2_f32_bf16 v17, v37, v13, v17
  v_dot2_f32_bf16 v16, v34, v14, v16
  v_dot2_f32_bf16 v17, v38, v14, v17
  v_dot2_f32_bf16 v16, v35, v15, v16
  v_dot2_f32_bf16 v17, v39, v15, v17
  v_dot2_f32_bf16 v18, v40, v12, 0
  v_dot2_f32_bf16 v19, v44, v12, 0
  v_dot2_f32_bf16 v18, v41, v13, v18
  v_dot2_f32_bf16 v19, v45, v13, v19
  v_dot2_f32_bf16 v18, v42, v14, v18
  v_dot2_f32_bf16 v19, v46, v14, v19
  v_dot2_f32_bf16 v18, v43, v15, v18
  v_dot2_f32_bf16 v19, v47, v15, v19
  s_nop 0
  s_cbranch_execz L_wret
  v_dot2_f32_bf16 v20, v48, v12, 0
  v_dot2_f32_bf16 v21, v52, v12, 0
  v_dot2_f32_bf16 v20, v49, v13, v20
  v_dot2_f32_bf16 v21, v53, v13, v21
  v_dot2_f32_bf16 v20, v50, v14, v20
  v_dot2_f32_bf16 v21, v54, v14, v21
  v_dot2_f32_bf16 v20, v51, v15, v20
  v_dot2_f32_bf16 v21, v55, v15, v21
  v_dot2_f32_bf16 v22, v56, v12, 0
  v_dot2_f32_bf16 v23, v60, v12, 0
  v_dot2_f32_bf16 v22, v57, v13, v22
  v_dot2_f32_bf16 v23, v61, v13, v23
  v_dot2_f32_bf16 v22, v58, v14, v22
  v_dot2_f32_bf16 v23, v62, v14, v23
  v_dot2_f32_bf16 v22, v59, v15, v22
  s_nop 0
  s_cbranch_execz L_wret
  v_dot2_f32_bf16 v23, v63, v15, v23
  v_dot2_f32_bf16 v24, v64, v12, 0
  v_dot2_f32_bf16 v25, v68, v12, 0
  v_dot2_f32_bf16 v24, v65, v13, v24
  v_dot2_f32_bf16 v25, v69, v13, v25
  v_dot2_f32_bf16 v24, v66, v14, v24
  v_dot2_f32_bf16 v25, v70, v14, v25
  v_dot2_f32_bf16 v24, v67, v15, v24
  v_dot2_f32_bf16 v25, v71, v15, v25
  v_dot2_f32_bf16 v26, v72, v12, 0
  v_dot2_f32_bf16 v27, v76, v12, 0
  v_dot2_f32_bf16 v26, v73, v13, v26
  v_dot2_f32_bf16 v27, v77, v13, v27
  v_dot2_f32_bf16 v26, v74, v14, v26
  v_dot2_f32_bf16 v27, v78, v14, v27
  s_nop 0
  s_cbranch_execz L_wret
  v_dot2_f32_bf16 v26, v75, v15, v26
  v_dot2_f32_bf16 v27, v79, v15, v27
  v_dot2_f32_bf16 v28, v80, v12, 0
  v_dot2_f32_bf16 v29, v84, v12, 0
  v_dot2_f32_bf16 v28, v81, v13, v28
  v_dot2_f32_bf16 v29, v85, v13, v29
  v_dot2_f32_bf16 v28, v82, v14, v28
  v_dot2_f32_bf16 v29, v86, v14, v29
  v_dot2_f32_bf16 v28, v83, v15, v28
  v_dot2_f32_bf16 v29, v87, v15, v29
  v_dot2_f32_bf16 v30, v88, v12, 0
  v_dot2_f32_bf16 v31, v92, v12, 0
  v_dot2_f32_bf16 v30, v89, v13, v30
  v_dot2_f32_bf16 v31, v93, v13, v31
  v_dot2_f32_bf16 v30, v90, v14, v30
  s_nop 0
  s_cbranch_execz L_wret
  v_dot2_f32_bf16 v31, v94, v14, v31
  v_dot2_f32_bf16 v30, v91, v15, v30
  v_dot2_f32_bf16 v31, v95, v15, v31
  v_add_f32_dpp v16, v16, v16 row_ror:8 row_mask:0xf bank_mask:0x3
  v_add_f32_dpp v17, v17, v17 row_ror:8 row_mask:0xf bank_mask:0x3
  v_add_f32_dpp v18, v18, v18 row_ror:8 row_mask:0xf bank_mask:0x3
  v_add_f32_dpp v19, v19, v19 row_ror:8 row_mask:0xf bank_mask:0x3
  v_add_f32_dpp v20, v20, v20 row_ror:8 row_mask:0xf bank_mask:0x3
  v_add_f32_dpp v21, v21, v21 row_ror:8 row_mask:0xf bank_mask:0x3
  v_add_f32_dpp v22, v22, v22 row_ror:8 row_mask:0xf bank_mask:0x3
  v_add_f32_dpp v23, v23, v23 row_ror:8 row_mask:0xf bank_mask:0x3
  v_add_f32_dpp v16, v24, v24 row_ror:8 row_mask:0xf bank_mask:0xc
  v_add_f32_dpp v17, v25, v25 row_ror:8 row_mask:0xf bank_mask:0xc
  v_add_f32_dpp v18, v26, v26 row_ror:8 row_mask:0xf bank_mask:0xc
  v_add_f32_dpp v19, v27, v27 row_ror:8 row_mask:0xf bank_mask:0xc
  s_nop 0
  s_cbranch_execz L_wret
  v_add_f32_dpp v20, v28, v28 row_ror:8 row_mask:0xf bank_mask:0xc
  v_add_f32_dpp v21, v29, v29 row_ror:8 row_mask:0xf bank_mask:0xc
  v_add_f32_dpp v22, v30, v30 row_ror:8 row_mask:0xf bank_mask:0xc
  v_add_f32_dpp v23, v31, v31 row_ror:8 row_mask:0xf bank_mask:0xc
  v_add_f32_dpp v16, v16, v16 row_shl:4 row_mask:0xf bank_mask:0x5
  v_add_f32_dpp v17, v17, v17 row_shl:4 row_mask:0xf bank_mask:0x5
  v_add_f32_dpp v18, v18, v18 row_shl:4 row_mask:0xf bank_mask:0x5
  v_add_f32_dpp v19, v19, v19 row_shl:4 row_mask:0xf bank_mask:0x5
  v_add_f32_dpp v16, v20, v20 row_shr:4 row_mask:0xf bank_mask:0xa
  v_add_f32_dpp v17, v21, v21 row_shr:4 row_mask:0xf bank_mask:0xa
  v_add_f32_dpp v18, v22, v22 row_shr:4 row_mask:0xf bank_mask:0xa
  v_add_f32_dpp v19, v23, v23 row_shr:4 row_mask:0xf bank_mask:0xa
  v_add_f32_dpp v16, v16, v16 quad_perm:[2,3,0,1] row_mask:0xf bank_mask:0xf
  v_add_f32_dpp v17, v17, v17 quad_perm:[2,3,0,1] row_mask:0xf bank_mask:0xf
  v_add_f32_dpp v18, v18, v18 quad_perm:[2,3,0,1] row_mask:0xf bank_mask:0xf
  s_nop 0
  s_cbranch_execz L_wret
  v_add_f32_dpp v19, v19, v19 quad_perm:[2,3,0,1] row_mask:0xf bank_mask:0xf
  v_cndmask_b32 v16, v16, v18, s[88:89]
  v_cndmask_b32 v17, v17, v19, s[88:89]
  s_nop 0
  v_add_f32_dpp v16, v16, v16 quad_perm:[1,0,3,2] row_mask:0xf bank_mask:0xf
  v_add_f32_dpp v17, v17, v17 quad_perm:[1,0,3,2] row_mask:0xf bank_mask:0xf
  v_cndmask_b32 v16, v16, v17, s[90:91]
  v_cvt_pk_bf16_f32 v16, v16, v16
  v_and_b32 v16, 0xffff0000, v16
  v_mul_f32 v16, 0x3db504f3, v16
  v_cvt_pk_bf16_f32 v16, v16, v16
  v_and_b32 v16, 0xffff0000, v16
  s_nop 1
  v_max_f32_dpp v17, v16, v16 row_ror:8 row_mask:0xf bank_mask:0xf
  s_nop 1
  v_max_f32_dpp v17, v17, v17 row_ror:4 row_mask:0xf bank_mask:0xf
  s_nop 1
  s_nop 0
  s_cbranch_execz L_wret
  v_max_f32_dpp v17, v17, v17 row_ror:2 row_mask:0xf bank_mask:0xf
  s_nop 1
  v_max_f32_dpp v17, v17, v17 row_ror:1 row_mask:0xf bank_mask:0xf
  v_mov_b32 v18, v17
  s_nop 1
  v_permlane16_swap_b32 v17, v18
  v_max_f32 v17, v17, v18
  v_mov_b32 v18, v17
  s_nop 1
  v_permlane32_swap_b32 v17, v18
  v_max_f32 v17, v17, v18
  ds_write_b32 v165, v17 offset:256
L_spin_4:
  ds_read_b128 v[20:23], v4 offset:256
  s_sub_u32 s34, s34, 1
  s_waitcnt lgkmcnt(0)
  s_cbranch_scc1 L_end
  v_max3_u32 v24, v20, v21, v22
  v_max_u32 v24, v24, v23
  v_cmp_eq_u32 vcc, -1, v24
  s_cbranch_vccnz L_spin_4
L_spino_5:
  v_max3_f32 v17, v20, v21, v22
  v_max_f32 v17, v17, v23
  v_sub_f32 v16, v16, v17
  v_mul_f32 v16, 0x3fb8aa3b, v16
  s_cbranch_execz L_wret
  v_exp_f32 v16, v16
  s_nop 0
  v_cvt_pk_bf16_f32 v19, v16, v16
  ds_write_b32 v167, v19 offset:512
  v_add_f32_dpp v17, v16, v16 row_ror:8 row_mask:0xf bank_mask:0xf
  s_nop 1
  v_add_f32_dpp v17, v17, v17 row_ror:4 row_mask:0xf bank_mask:0xf
  s_nop 1
  v_add_f32_dpp v17, v17, v17 row_ror:2 row_mask:0xf bank_mask:0xf
  s_nop 1
  v_add_f32_dpp v17, v17, v17 row_ror:1 row_mask:0xf bank_mask:0xf
  v_mov_b32 v18, v17
  s_nop 1
  v_permlane16_swap_b32 v17, v18
  v_add_f32 v17, v17, v18
  v_mov_b32 v18, v17
  s_nop 1
  v_permlane32_swap_b32 v17, v18
  v_add_f32 v17, v17, v18
  ds_write_b32 v165, v17 offset:272
  s_endpgm
L_V:
  v_and_b32 v12, 1, v2
  v_lshlrev_b32 v12, 4, v12
  s_nop 0
  s_cbranch_execz L_wret
  v_mov_b32 v13, 0xffff
  v_lshlrev_b32 v12, v12, v13
  v_lshrrev_b32 v13, 1, v2
  v_cmp_eq_u32 vcc, 0, v13
  s_nop 1
  v_cndmask_b32 v8, 0, v12, vcc
  v_cmp_eq_u32 vcc, 1, v13
  s_nop 1
  v_cndmask_b32 v9, 0, v12, vcc
  v_cmp_eq_u32 vcc, 2, v13
  s_nop 1
  v_cndmask_b32 v10, 0, v12, vcc
  v_cmp_eq_u32 vcc, 3, v13
  s_nop 1
  v_cndmask_b32 v11, 0, v12, vcc
  v_and_b32 v7, 1, v3
  v_lshlrev_b32 v7, 4, v7
  v_lshl_add_u32 v7, v2, 5, v7
  s_lshl_b32 s56, s30, 9
  v_add_u32 v164, s56, v7
  s_lshl_b32 s57, s35, 9
  s_add_u32 s57, s57, 655360
  v_mov_b32 v12, 1
  s_load_dword s31, s[26:27], 0
  s_mov_b32 s40, s8
  s_mov_b32 s41, s9
  s_mov_b32 s36, s26
  s_cbranch_execz L_wret
  s_mov_b32 s37, s27
  s_mov_b32 s38, 0x200000
  s_mov_b32 s39, 0x20000
  s_waitcnt lgkmcnt(0)
  s_mul_i32 s31, s31, 1664525
  s_add_u32 s31, s31, 1013904223
L_ks_6:
  s_sleep 1
  ds_read_b32 v13, v165 offset:368
  s_sub_u32 s34, s34, 1
  s_waitcnt lgkmcnt(0)
  s_cbranch_scc1 L_end
  v_cmp_gt_i32 vcc, 4, v13
  s_cbranch_vccnz L_ks_6
  buffer_load_dwordx4 v[96:99], v6, s[40:43], s52 offen offset:0 nt
  buffer_load_dwordx4 v[100:103], v6, s[40:43], s52 offen offset:1024 nt
L_ks_7:
  s_sleep 1
  ds_read_b32 v13, v165 offset:368
  s_sub_u32 s34, s34, 1
  s_waitcnt lgkmcnt(0)
  s_cbranch_scc1 L_end
  v_cmp_gt_i32 vcc, 5, v13
  s_cbranch_vccnz L_ks_7
  s_nop 0
  s_cbranch_execz L_wret
  buffer_load_dwordx4 v[104:107], v6, s[40:43], s52 offen offset:2048 nt
  buffer_load_dwordx4 v[108:111], v6, s[40:43], s52 offen offset:3072 nt
L_ks_8:
  s_sleep 1
  ds_read_b32 v13, v165 offset:368
  s_sub_u32 s34, s34, 1
  s_waitcnt lgkmcnt(0)
  s_cbranch_scc1 L_end
  v_cmp_gt_i32 vcc, 6, v13
  s_cbranch_vccnz L_ks_8
  buffer_load_dwordx4 v[112:115], v6, s[40:43], s53 offen offset:0 nt
  buffer_load_dwordx4 v[116:119], v6, s[40:43], s53 offen offset:1024 nt
L_ks_9:
  s_sleep 1
  ds_read_b32 v13, v165 offset:368
  s_sub_u32 s34, s34, 1
  s_waitcnt lgkmcnt(0)
  s_cbranch_scc1 L_end
  v_cmp_gt_i32 vcc, 7, v13
  s_cbranch_vccnz L_ks_9
  buffer_load_dwordx4 v[120:123], v6, s[40:43], s53 offen offset:2048 nt
  buffer_load_dwordx4 v[124:127], v6, s[40:43], s53 offen offset:3072 nt
L_ks_10:
  s_sleep 1
  ds_read_b32 v13, v165 offset:368
  s_cbranch_execz L_wret
  s_sub_u32 s34, s34, 1
  s_waitcnt lgkmcnt(0)
  s_cbranch_scc1 L_end
  v_cmp_gt_i32 vcc, 8, v13
  s_cbranch_vccnz L_ks_10
  buffer_load_dwordx4 v[128:131], v6, s[40:43], s54 offen offset:0 nt
  buffer_load_dwordx4 v[132:135], v6, s[40:43], s54 offen offset:1024 nt
  buffer_load_dwordx4 v[136:139], v6, s[40:43], s54 offen offset:2048 nt
  buffer_load_dwordx4 v[140:143], v6, s[40:43], s54 offen offset:3072 nt
  s_waitcnt vmcnt(11)
  buffer_load_dwordx4 v[144:147], v6, s[40:43], s55 offen offset:0 nt
  s_waitcnt vmcnt(11)
  buffer_load_dwordx4 v[148:151], v6, s[40:43], s55 offen offset:1024 nt
  s_waitcnt vmcnt(11)
  buffer_load_dwordx4 v[152:155], v6, s[40:43], s55 offen offset:2048 nt
  s_waitcnt vmcnt(11)
  buffer_load_dwordx4 v[156:159], v6, s[40:43], s55 offen offset:3072 nt
  s_mov_b64 exec, 1
  ds_add_u32 v4, v12 offset:356
  s_mov_b64 exec, -1
L_spin_11:
  ds_read_b32 v19, v167 offset:512
  s_cbranch_execz L_wret
  s_sub_u32 s34, s34, 1
  s_waitcnt lgkmcnt(0)
  s_cbranch_scc1 L_end
  v_cmp_eq_u32 vcc, -1, v19
  s_cbranch_vccnz L_spin_11
L_spino_12:
  ds_read_b32 v16, v4 offset:352
  v_and_b32_dpp v32, v19, v8 row_newbcast:0 row_mask:0xf bank_mask:0xf
  v_and_b32_dpp v33, v19, v9 row_newbcast:0 row_mask:0xf bank_mask:0xf
  v_and_b32_dpp v34, v19, v10 row_newbcast:0 row_mask:0xf bank_mask:0xf
  v_and_b32_dpp v35, v19, v11 row_newbcast:0 row_mask:0xf bank_mask:0xf
  v_and_b32_dpp v36, v19, v8 row_newbcast:1 row_mask:0xf bank_mask:0xf
  v_and_b32_dpp v37, v19, v9 row_newbcast:1 row_mask:0xf bank_mask:0xf
  v_and_b32_dpp v38, v19, v10 row_newbcast:1 row_mask:0xf bank_mask:0xf
  v_and_b32_dpp v39, v19, v11 row_newbcast:1 row_mask:0xf bank_mask:0xf
  v_and_b32_dpp v40, v19, v8 row_newbcast:2 row_mask:0xf bank_mask:0xf
  v_and_b32_dpp v41, v19, v9 row_newbcast:2 row_mask:0xf bank_mask:0xf
  v_and_b32_dpp v42, v19, v10 row_newbcast:2 row_mask:0xf bank_mask:0xf
  v_and_b32_dpp v43, v19, v11 row_newbcast:2 row_mask:0xf bank_mask:0xf
  s_cbranch_execz L_wret
  v_and_b32_dpp v44, v19, v8 row_newbcast:3 row_mask:0xf bank_mask:0xf
  v_and_b32_dpp v45, v19, v9 row_newbcast:3 row_mask:0xf bank_mask:0xf
  v_and_b32_dpp v46, v19, v10 row_newbcast:3 row_mask:0xf bank_mask:0xf
  v_and_b32_dpp v47, v19, v11 row_newbcast:3 row_mask:0xf bank_mask:0xf
  v_and_b32_dpp v48, v19, v8 row_newbcast:4 row_mask:0xf bank_mask:0xf
  v_and_b32_dpp v49, v19, v9 row_newbcast:4 row_mask:0xf bank_mask:0xf
  v_and_b32_dpp v50, v19, v10 row_newbcast:4 row_mask:0xf bank_mask:0xf
  v_and_b32_dpp v51, v19, v11 row_newbcast:4 row_mask:0xf bank_mask:0xf
  v_and_b32_dpp v52, v19, v8 row_newbcast:5 row_mask:0xf bank_mask:0xf
  v_and_b32_dpp v53, v19, v9 row_newbcast:5 row_mask:0xf bank_mask:0xf
  v_and_b32_dpp v54, v19, v10 row_newbcast:5 row_mask:0xf bank_mask:0xf
  v_and_b32_dpp v55, v19, v11 row_newbcast:5 row_mask:0xf bank_mask:0xf
  v_and_b32_dpp v56, v19, v8 row_newbcast:6 row_mask:0xf bank_mask:0xf
  v_and_b32_dpp v57, v19, v9 row_newbcast:6 row_mask:0xf bank_mask:0xf
  v_and_b32_dpp v58, v19, v10 row_newbcast:6 row_mask:0xf bank_mask:0xf
  s_nop 0
  s_cbranch_execz L_wret
  v_and_b32_dpp v59, v19, v11 row_newbcast:6 row_mask:0xf bank_mask:0xf
  v_and_b32_dpp v60, v19, v8 row_newbcast:7 row_mask:0xf bank_mask:0xf
  v_and_b32_dpp v61, v19, v9 row_newbcast:7 row_mask:0xf bank_mask:0xf
  v_and_b32_dpp v62, v19, v10 row_newbcast:7 row_mask:0xf bank_mask:0xf
  v_and_b32_dpp v63, v19, v11 row_newbcast:7 row_mask:0xf bank_mask:0xf
  v_and_b32_dpp v64, v19, v8 row_newbcast:8 row_mask:0xf bank_mask:0xf
  v_and_b32_dpp v65, v19, v9 row_newbcast:8 row_mask:0xf bank_mask:0xf
  v_and_b32_dpp v66, v19, v10 row_newbcast:8 row_mask:0xf bank_mask:0xf
  v_and_b32_dpp v67, v19, v11 row_newbcast:8 row_mask:0xf bank_mask:0xf
  v_and_b32_dpp v68, v19, v8 row_newbcast:9 row_mask:0xf bank_mask:0xf
  v_and_b32_dpp v69, v19, v9 row_newbcast:9 row_mask:0xf bank_mask:0xf
  v_and_b32_dpp v70, v19, v10 row_newbcast:9 row_mask:0xf bank_mask:0xf
  v_and_b32_dpp v71, v19, v11 row_newbcast:9 row_mask:0xf bank_mask:0xf
  v_and_b32_dpp v72, v19, v8 row_newbcast:10 row_mask:0xf bank_mask:0xf
  v_and_b32_dpp v73, v19, v9 row_newbcast:10 row_mask:0xf bank_mask:0xf
  s_nop 0
  s_cbranch_execz L_wret
  v_and_b32_dpp v74, v19, v10 row_newbcast:10 row_mask:0xf bank_mask:0xf
  v_and_b32_dpp v75, v19, v11 row_newbcast:10 row_mask:0xf bank_mask:0xf
  v_and_b32_dpp v76, v19, v8 row_newbcast:11 row_mask:0xf bank_mask:0xf
  v_and_b32_dpp v77, v19, v9 row_newbcast:11 row_mask:0xf bank_mask:0xf
  v_and_b32_dpp v78, v19, v10 row_newbcast:11 row_mask:0xf bank_mask:0xf
  v_and_b32_dpp v79, v19, v11 row_newbcast:11 row_mask:0xf bank_mask:0xf
  v_and_b32_dpp v80, v19, v8 row_newbcast:12 row_mask:0xf bank_mask:0xf
  v_and_b32_dpp v81, v19, v9 row_newbcast:12 row_mask:0xf bank_mask:0xf
  v_and_b32_dpp v82, v19, v10 row_newbcast:12 row_mask:0xf bank_mask:0xf
  v_and_b32_dpp v83, v19, v11 row_newbcast:12 row_mask:0xf bank_mask:0xf
  v_and_b32_dpp v84, v19, v8 row_newbcast:13 row_mask:0xf bank_mask:0xf
  v_and_b32_dpp v85, v19, v9 row_newbcast:13 row_mask:0xf bank_mask:0xf
  v_and_b32_dpp v86, v19, v10 row_newbcast:13 row_mask:0xf bank_mask:0xf
  v_and_b32_dpp v87, v19, v11 row_newbcast:13 row_mask:0xf bank_mask:0xf
  v_and_b32_dpp v88, v19, v8 row_newbcast:14 row_mask:0xf bank_mask:0xf
  s_nop 0
  s_cbranch_execz L_wret
  v_and_b32_dpp v89, v19, v9 row_newbcast:14 row_mask:0xf bank_mask:0xf
  v_and_b32_dpp v90, v19, v10 row_newbcast:14 row_mask:0xf bank_mask:0xf
  v_and_b32_dpp v91, v19, v11 row_newbcast:14 row_mask:0xf bank_mask:0xf
  v_and_b32_dpp v92, v19, v8 row_newbcast:15 row_mask:0xf bank_mask:0xf
  v_and_b32_dpp v93, v19, v9 row_newbcast:15 row_mask:0xf bank_mask:0xf
  v_and_b32_dpp v94, v19, v10 row_newbcast:15 row_mask:0xf bank_mask:0xf
  v_and_b32_dpp v95, v19, v11 row_newbcast:15 row_mask:0xf bank_mask:0xf
  s_waitcnt lgkmcnt(0)
  v_readfirstlane_b32 s58, v16
  s_waitcnt vmcnt(15)
  v_mfma_f32_16x16x32_bf16 v[160:163], v[32:35], v[96:99], 0
  s_waitcnt vmcnt(14)
  v_mfma_f32_16x16x32_bf16 v[160:163], v[36:39], v[100:103], v[160:163]
  s_waitcnt vmcnt(13)
  v_mfma_f32_16x16x32_bf16 v[160:163], v[40:43], v[104:107], v[160:163]
  s_waitcnt vmcnt(12)
  v_mfma_f32_16x16x32_bf16 v[160:163], v[44:47], v[108:111], v[160:163]
  s_waitcnt vmcnt(11)
  v_mfma_f32_16x16x32_bf16 v[160:163], v[48:51], v[112:115], v[160:163]
  s_cbranch_execz L_wret
  s_waitcnt vmcnt(10)
  v_mfma_f32_16x16x32_bf16 v[160:163], v[52:55], v[116:119], v[160:163]
  s_waitcnt vmcnt(9)
  v_mfma_f32_16x16x32_bf16 v[160:163], v[56:59], v[120:123], v[160:163]
  s_waitcnt vmcnt(8)
  v_mfma_f32_16x16x32_bf16 v[160:163], v[60:63], v[124:127], v[160:163]
  s_waitcnt vmcnt(7)
  v_mfma_f32_16x16x32_bf16 v[160:163], v[64:67], v[128:131], v[160:163]
  s_waitcnt vmcnt(6)
  v_mfma_f32_16x16x32_bf16 v[160:163], v[68:71], v[132:135], v[160:163]
  s_waitcnt vmcnt(5)
  v_mfma_f32_16x16x32_bf16 v[160:163], v[72:75], v[136:139], v[160:163]
  s_waitcnt vmcnt(4)
  v_mfma_f32_16x16x32_bf16 v[160:163], v[76:79], v[140:143], v[160:163]
  s_waitcnt vmcnt(3)
  v_mfma_f32_16x16x32_bf16 v[160:163], v[80:83], v[144:147], v[160:163]
  s_waitcnt vmcnt(2)
  v_mfma_f32_16x16x32_bf16 v[160:163], v[84:87], v[148:151], v[160:163]
  s_waitcnt vmcnt(1)
  v_mfma_f32_16x16x32_bf16 v[160:163], v[88:91], v[152:155], v[160:163]
  s_waitcnt vmcnt(0)
  s_cbranch_execz L_wret
  v_mfma_f32_16x16x32_bf16 v[160:163], v[92:95], v[156:159], v[160:163]
  s_mov_b64 exec, 0xffffffff
  s_nop 6
  ds_write_b128 v164, v[160:163] offset:1536
  s_mov_b64 exec, 1
  ds_add_rtn_u32 v13, v4, v12 offset:360
  s_mov_b64 exec, 0xffffffff
  ds_read_b128 v[16:19], v7 offset:1536
  ds_read_b128 v[20:23], v7 offset:2048
  ds_read_b128 v[24:27], v7 offset:2560
  ds_read_b128 v[28:31], v7 offset:3072
  s_waitcnt lgkmcnt(0)
  v_readfirstlane_b32 s56, v13
  v_pk_add_f32 v[16:17], v[16:17], v[20:21]
  v_pk_add_f32 v[18:19], v[18:19], v[22:23]
  s_cmp_eq_u32 s56, 2
  s_cbranch_scc0 L_s_end
  v_pk_add_f32 v[24:25], v[24:25], v[28:29]
  s_nop 0
  s_cbranch_execz L_wret
  v_pk_add_f32 v[26:27], v[26:27], v[30:31]
  v_pk_add_f32 v[16:17], v[16:17], v[24:25]
  v_pk_add_f32 v[18:19], v[18:19], v[26:27]
  s_cmp_eq_u32 s58, 1
  v_bfi_b32 v16, v5, s31, v16
  v_bfi_b32 v17, v5, s31, v17
  v_bfi_b32 v18, v5, s31, v18
  v_bfi_b32 v19, v5, s31, v19
  s_cbranch_scc1 L_s_fast
  buffer_store_dwordx4 v[16:19], v7, s[36:39], s57 offen sc1
  s_branch L_s_pub
L_s_fast:
  buffer_store_dwordx4 v[16:19], v7, s[36:39], s57 offen
L_s_pub:
  v_and_b32 v20, v5, v16
  ds_write_b32 v4, v20 offset:364
L_s_end:
  s_endpgm
L_T:
  s_setprio 3
  v_lshlrev_b32 v6, 2, v1
  v_mov_b32 v12, -1
  v_mov_b32 v13, -1
  v_mov_b32 v14, -1
  v_mov_b32 v15, -1
  s_cbranch_execz L_wret
  v_lshlrev_b32 v7, 4, v1
  ds_write_b32 v6, v12 offset:256
  ds_write_b128 v7, v[12:15] offset:512
  s_waitcnt lgkmcnt(0)
  s_barrier
  v_lshlrev_b32 v6, 14, v3
  v_lshl_add_u32 v6, v2, 4, v6
  s_lshr_b32 s58, s29, 2
  s_lshl_b32 s59, s28, 1
  s_add_u32 s58, s58, s59
  s_and_b32 s59, s29, 3
  s_lshl_b32 s59, s59, 6
  s_add_u32 s59, s59, s58
  s_lshl_b32 s52, s58, 16
  s_and_b32 s53, s29, 3
  s_lshl_b32 s53, s53, 8
  s_add_u32 s52, s52, s53
  s_add_u32 s53, s52, 0x1000
  s_add_u32 s54, s52, 0x2000
  s_add_u32 s55, s52, 0x3000
  s_mov_b32 s42, 0x400000
  s_mov_b32 s43, 0x20000
  s_mov_b32 s40, s12
  s_cbranch_execz L_wret
  s_mov_b32 s41, s13
  s_mov_b32 s36, s26
  s_mov_b32 s37, s27
  s_mov_b32 s38, 0x200000
  s_mov_b32 s39, 0x20000
  s_mov_b32 s86, 0x05040100
  s_mov_b32 s87, 0x07060302
  s_mov_b32 s88, 0xffff0000
  s_mov_b32 s89, 0xffff0000
  v_and_b32 v8, 1, v3
  v_lshlrev_b32 v8, 4, v8
  v_lshl_add_u32 v8, v2, 5, v8
  v_lshrrev_b32 v9, 1, v3
  v_lshl_add_u32 v8, v9, 9, v8
  v_lshrrev_b32 v9, 7, v8
  v_and_b32 v8, 127, v8
  v_lshl_add_u32 v8, v9, 13, v8
  s_lshl_b32 s60, s33, 16
  s_lshl_b32 s61, s58, 7
  s_add_u32 s60, s60, s61
  s_nop 0
  s_cbranch_execz L_wret
  s_add_u32 s60, s60, 1048576
  v_lshlrev_b32 v167, 4, v1
  v_lshrrev_b32 v27, 3, v2
  v_lshlrev_b32 v166, 4, v27
  v_lshlrev_b32 v7, 11, v27
  v_lshl_add_u32 v7, v3, 6, v7
  v_and_b32 v27, 7, v2
  v_lshl_add_u32 v7, v27, 3, v7
  s_lshl_b32 s56, s28, 12
  s_lshr_b32 s57, s29, 2
  s_lshl_b32 s57, s57, 8
  s_add_u32 s56, s56, s57
  s_add_u32 s56, s56, 655360
L_T_tail:
L_trig_32:
  s_sleep 1
  ds_read_b32 v27, v4 offset:356
  s_sub_u32 s34, s34, 1
  s_waitcnt lgkmcnt(0)
  s_cbranch_scc1 L_end
  v_cmp_gt_i32 vcc, 3, v27
  s_cbranch_vccnz L_trig_32
L_trigo_33:
  buffer_load_dwordx4 v[96:99], v6, s[40:43], s52 offen offset:0 nt
  buffer_load_dwordx4 v[100:103], v6, s[40:43], s52 offen offset:1024 nt
  buffer_load_dwordx4 v[104:107], v6, s[40:43], s52 offen offset:2048 nt
  s_cbranch_execz L_wret
  buffer_load_dwordx4 v[108:111], v6, s[40:43], s52 offen offset:3072 nt
  buffer_load_dwordx4 v[112:115], v6, s[40:43], s53 offen offset:0 nt
  buffer_load_dwordx4 v[116:119], v6, s[40:43], s53 offen offset:1024 nt
  buffer_load_dwordx4 v[120:123], v6, s[40:43], s53 offen offset:2048 nt
  buffer_load_dwordx4 v[124:127], v6, s[40:43], s53 offen offset:3072 nt
  buffer_load_dwordx4 v[128:131], v6, s[40:43], s54 offen offset:0 nt
  buffer_load_dwordx4 v[132:135], v6, s[40:43], s54 offen offset:1024 nt
  buffer_load_dwordx4 v[136:139], v6, s[40:43], s54 offen offset:2048 nt
  buffer_load_dwordx4 v[140:143], v6, s[40:43], s54 offen offset:3072 nt
  buffer_load_dwordx4 v[144:147], v6, s[40:43], s55 offen offset:0 nt
  buffer_load_dwordx4 v[148:151], v6, s[40:43], s55 offen offset:1024 nt
  buffer_load_dwordx4 v[152:155], v6, s[40:43], s55 offen offset:2048 nt
  buffer_load_dwordx4 v[156:159], v6, s[40:43], s55 offen offset:3072 nt
L_spin_34:
  s_sleep 1
  ds_read_b32 v44, v4 offset:320
  s_sub_u32 s34, s34, 1
  s_waitcnt lgkmcnt(0)
  s_cbranch_execz L_wret
  s_cbranch_scc1 L_end
  v_cmp_eq_u32 vcc, -1, v44
  s_cbranch_vccnz L_spin_34
L_spino_35:
  ds_read_b128 v[160:163], v167 offset:3584
L_spin_36:
  ds_read_b32 v27, v4 offset:364
  s_sub_u32 s34, s34, 1
  s_waitcnt lgkmcnt(0)
  s_cbranch_scc1 L_end
  v_cmp_eq_u32 vcc, -1, v27
  s_cbranch_vccnz L_spin_36
L_spino_37:
  v_readfirstlane_b32 s31, v27
  buffer_load_dwordx2 v[10:11], v7, s[36:39], s56 offen offset:0 sc1
  buffer_load_dwordx2 v[12:13], v7, s[36:39], s56 offen offset:512 sc1
  buffer_load_dwordx2 v[14:15], v7, s[36:39], s56 offen offset:1024 sc1
  buffer_load_dwordx2 v[16:17], v7, s[36:39], s56 offen offset:1536 sc1
  s_waitcnt vmcnt(18)
  v_perm_b32 v32, v100, v96, s86
  v_perm_b32 v36, v100, v96, s87
  v_perm_b32 v40, v101, v97, s86
  v_perm_b32 v44, v101, v97, s87
  s_nop 0
  s_cbranch_execz L_wret
  v_perm_b32 v48, v102, v98, s86
  v_perm_b32 v52, v102, v98, s87
  v_perm_b32 v56, v103, v99, s86
  v_perm_b32 v60, v103, v99, s87
  s_waitcnt vmcnt(16)
  v_perm_b32 v33, v108, v104, s86
  v_perm_b32 v37, v108, v104, s87
  v_perm_b32 v41, v109, v105, s86
  v_perm_b32 v45, v109, v105, s87
  v_perm_b32 v49, v110, v106, s86
  v_perm_b32 v53, v110, v106, s87
  v_perm_b32 v57, v111, v107, s86
  v_perm_b32 v61, v111, v107, s87
  s_waitcnt vmcnt(14)
  v_perm_b32 v34, v116, v112, s86
  v_perm_b32 v38, v116, v112, s87
  s_nop 0
  s_cbranch_execz L_wret
  v_perm_b32 v42, v117, v113, s86
  v_perm_b32 v46, v117, v113, s87
  v_perm_b32 v50, v118, v114, s86
  v_perm_b32 v54, v118, v114, s87
  v_perm_b32 v58, v119, v115, s86
  v_perm_b32 v62, v119, v115, s87
  s_waitcnt vmcnt(12)
  v_perm_b32 v35, v124, v120, s86
  v_perm_b32 v39, v124, v120, s87
  v_perm_b32 v43, v125, v121, s86
  v_perm_b32 v47, v125, v121, s87
  v_perm_b32 v51, v126, v122, s86
  v_perm_b32 v55, v126, v122, s87
  v_perm_b32 v59, v127, v123, s86
  v_perm_b32 v63, v127, v123, s87
  v_mov_b32 v96, v160
  v_mov_b32 v100, v161
  s_cbranch_execz L_wret
  v_mov_b32 v104, v162
  v_mov_b32 v108, v163
  v_mov_b32 v112, v160
  v_mov_b32 v116, v161
  v_mov_b32 v120, v162
  v_mov_b32 v124, v163
  s_waitcnt vmcnt(10)
  v_perm_b32 v64, v132, v128, s86
  v_perm_b32 v68, v132, v128, s87
  v_perm_b32 v72, v133, v129, s86
  v_perm_b32 v76, v133, v129, s87
  v_perm_b32 v80, v134, v130, s86
  v_perm_b32 v84, v134, v130, s87
  v_perm_b32 v88, v135, v131, s86
  v_perm_b32 v92, v135, v131, s87
  s_waitcnt vmcnt(8)
  v_perm_b32 v65, v140, v136, s86
  v_perm_b32 v69, v140, v136, s87
  v_perm_b32 v73, v141, v137, s86
  s_nop 0
  s_cbranch_execz L_wret
  v_perm_b32 v77, v141, v137, s87
  v_perm_b32 v81, v142, v138, s86
  v_perm_b32 v85, v142, v138, s87
  v_perm_b32 v89, v143, v139, s86
  v_perm_b32 v93, v143, v139, s87
  s_waitcnt vmcnt(6)
  v_perm_b32 v66, v148, v144, s86
  v_perm_b32 v70, v148, v144, s87
  v_perm_b32 v74, v149, v145, s86
  v_perm_b32 v78, v149, v145, s87
  v_perm_b32 v82, v150, v146, s86
  v_perm_b32 v86, v150, v146, s87
  v_perm_b32 v90, v151, v147, s86
  v_perm_b32 v94, v151, v147, s87
  s_waitcnt vmcnt(4)
  v_perm_b32 v67, v156, v152, s86
  s_nop 0
  s_cbranch_execz L_wret
  v_perm_b32 v71, v156, v152, s87
  v_perm_b32 v75, v157, v153, s86
  v_perm_b32 v79, v157, v153, s87
  v_perm_b32 v83, v158, v154, s86
  v_perm_b32 v87, v158, v154, s87
  v_perm_b32 v91, v159, v155, s86
  v_perm_b32 v95, v159, v155, s87
L_spin_38:
  ds_read_b128 v[26:29], v166 offset:288
  s_sub_u32 s34, s34, 1
  s_waitcnt lgkmcnt(0)
  s_cbranch_scc1 L_end
  v_max3_u32 v30, v26, v27, v28
  v_max_u32 v30, v30, v29
  v_cmp_eq_u32 vcc, -1, v30
  s_cbranch_vccnz L_spin_38
L_spino_39:
  s_waitcnt vmcnt(0)
  v_xor_b32 v31, s31, v10
  v_bitop3_b32 v31, v31, v11, s31 bitop3:0xf6
  v_bitop3_b32 v31, v31, v12, s31 bitop3:0xf6
  s_nop 0
  s_cbranch_execz L_wret
  v_bitop3_b32 v31, v31, v13, s31 bitop3:0xf6
  v_bitop3_b32 v31, v31, v14, s31 bitop3:0xf6
  v_bitop3_b32 v31, v31, v15, s31 bitop3:0xf6
  v_bitop3_b32 v31, v31, v16, s31 bitop3:0xf6
  v_bitop3_b32 v31, v31, v17, s31 bitop3:0xf6
  v_and_b32 v31, v5, v31
  v_cmp_ne_u32 vcc, 0, v31
  s_cbranch_vccz L_o_ok
L_poll_40:
  buffer_load_dwordx2 v[10:11], v7, s[36:39], s56 offen offset:0 sc1
  buffer_load_dwordx2 v[12:13], v7, s[36:39], s56 offen offset:512 sc1
  buffer_load_dwordx2 v[14:15], v7, s[36:39], s56 offen offset:1024 sc1
  buffer_load_dwordx2 v[16:17], v7, s[36:39], s56 offen offset:1536 sc1
  s_sub_u32 s34, s34, 64
  s_waitcnt vmcnt(0)
  s_cbranch_scc1 L_end
  v_xor_b32 v31, s31, v10
  v_bitop3_b32 v31, v31, v11, s31 bitop3:0xf6
  v_bitop3_b32 v31, v31, v12, s31 bitop3:0xf6
  v_bitop3_b32 v31, v31, v13, s31 bitop3:0xf6
  s_cbranch_execz L_wret
  v_bitop3_b32 v31, v31, v14, s31 bitop3:0xf6
  v_bitop3_b32 v31, v31, v15, s31 bitop3:0xf6
  v_bitop3_b32 v31, v31, v16, s31 bitop3:0xf6
  v_bitop3_b32 v31, v31, v17, s31 bitop3:0xf6
  v_and_b32 v31, v5, v31
  v_cmp_ne_u32 vcc, 0, v31
  s_cbranch_vccnz L_poll_40
L_pollo_41:
L_o_ok:
  v_mul_f32 v10, v10, v26
  v_mul_f32 v11, v11, v26
  v_fmac_f32 v10, v12, v27
  v_fmac_f32 v11, v13, v27
  v_fmac_f32 v10, v14, v28
  v_fmac_f32 v11, v15, v28
  v_fmac_f32 v10, v16, v29
  v_fmac_f32 v11, v17, v29
  v_cvt_pk_bf16_f32 v9, v10, v11
  s_nop 1
  v_mov_b32_dpp v18, v9 row_newbcast:0 row_mask:0xf bank_mask:0x3
  v_mov_b32_dpp v18, v9 row_newbcast:8 row_mask:0xf bank_mask:0xc
  v_mov_b32_dpp v19, v9 row_newbcast:1 row_mask:0xf bank_mask:0x3
  v_mov_b32_dpp v19, v9 row_newbcast:9 row_mask:0xf bank_mask:0xc
  s_nop 0
  s_cbranch_execz L_wret
  v_mov_b32_dpp v20, v9 row_newbcast:2 row_mask:0xf bank_mask:0x3
  v_mov_b32_dpp v20, v9 row_newbcast:10 row_mask:0xf bank_mask:0xc
  v_mov_b32_dpp v21, v9 row_newbcast:3 row_mask:0xf bank_mask:0x3
  v_mov_b32_dpp v21, v9 row_newbcast:11 row_mask:0xf bank_mask:0xc
  s_nop 1
  v_mfma_f32_16x16x32_bf16 v[96:99], v[18:21], v[32:35], v[96:99]
  v_mov_b32_dpp v22, v9 row_newbcast:4 row_mask:0xf bank_mask:0x3
  v_mov_b32_dpp v22, v9 row_newbcast:12 row_mask:0xf bank_mask:0xc
  v_mfma_f32_16x16x32_bf16 v[100:103], v[18:21], v[36:39], v[100:103]
  v_mov_b32_dpp v23, v9 row_newbcast:5 row_mask:0xf bank_mask:0x3
  v_mov_b32_dpp v23, v9 row_newbcast:13 row_mask:0xf bank_mask:0xc
  v_mfma_f32_16x16x32_bf16 v[104:107], v[18:21], v[40:43], v[104:107]
  v_mov_b32_dpp v24, v9 row_newbcast:6 row_mask:0xf bank_mask:0x3
  v_mov_b32_dpp v24, v9 row_newbcast:14 row_mask:0xf bank_mask:0xc
  v_mfma_f32_16x16x32_bf16 v[108:111], v[18:21], v[44:47], v[108:111]
  v_mov_b32_dpp v25, v9 row_newbcast:7 row_mask:0xf bank_mask:0x3
  s_cbranch_execz L_wret
  v_mov_b32_dpp v25, v9 row_newbcast:15 row_mask:0xf bank_mask:0xc
  v_mfma_f32_16x16x32_bf16 v[112:115], v[18:21], v[48:51], v[112:115]
  v_mfma_f32_16x16x32_bf16 v[116:119], v[18:21], v[52:55], v[116:119]
  v_mfma_f32_16x16x32_bf16 v[120:123], v[18:21], v[56:59], v[120:123]
  v_mfma_f32_16x16x32_bf16 v[124:127], v[18:21], v[60:63], v[124:127]
  v_mfma_f32_16x16x32_bf16 v[96:99], v[22:25], v[64:67], v[96:99]
  v_mfma_f32_16x16x32_bf16 v[100:103], v[22:25], v[68:71], v[100:103]
  v_mfma_f32_16x16x32_bf16 v[104:107], v[22:25], v[72:75], v[104:107]
  v_mfma_f32_16x16x32_bf16 v[108:111], v[22:25], v[76:79], v[108:111]
  v_mfma_f32_16x16x32_bf16 v[112:115], v[22:25], v[80:83], v[112:115]
  v_mfma_f32_16x16x32_bf16 v[116:119], v[22:25], v[84:87], v[116:119]
  v_mfma_f32_16x16x32_bf16 v[120:123], v[22:25], v[88:91], v[120:123]
  v_mfma_f32_16x16x32_bf16 v[124:127], v[22:25], v[92:95], v[124:127]
  s_nop 6
  v_cndmask_b32 v160, v96, v112, s[88:89]
  v_cndmask_b32 v161, v100, v116, s[88:89]
  s_cbranch_execz L_wret
  v_cndmask_b32 v162, v104, v120, s[88:89]
  v_cndmask_b32 v163, v108, v124, s[88:89]
  v_bfi_b32 v160, v5, s31, v160
  v_bfi_b32 v161, v5, s31, v161
  v_bfi_b32 v162, v5, s31, v162
  v_bfi_b32 v163, v5, s31, v163
  buffer_store_dwordx4 v[160:163], v8, s[36:39], s60 offen sc1
  ds_write_b32 v4, v4 offset:384
  s_endpgm
L_end:
  s_endpgm
.section .rodata,"a"
.p2align 6
.amdhsa_kernel parallel_sum__sliding_block_cached__glu_gated_glu__decode_kernel
  .amdhsa_next_free_vgpr 168
  .amdhsa_next_free_sgpr 102
  .amdhsa_accum_offset 168
  .amdhsa_group_segment_fixed_size 0
  .amdhsa_kernarg_size 96
  .amdhsa_user_sgpr_count 2
  .amdhsa_user_sgpr_kernarg_segment_ptr 1
  .amdhsa_system_sgpr_workgroup_id_x 1
  .amdhsa_float_denorm_mode_32 3
.end_amdhsa_kernel
```
